```python
import torch

def _softmax(x, axis=-1):
    return torch.softmax(x, dim=axis)

def _gelu(x):
    return torch.nn.functional.gelu(x, approximate='tanh')

def _silu(x):
    return torch.nn.functional.silu(x)

def _sigmoid(x):
    return torch.sigmoid(x)

def _layernorm(x, axis=-1, eps=1e-05):
    m = x.mean(dim=axis, keepdim=True)
    v = x.var(dim=axis, keepdim=True, unbiased=False)
    return (x - m) / torch.sqrt(v + eps)

def _scatter_add(tgt, idx, src, axis=0):
    return tgt.clone().index_add_(axis, idx, src)

def _segment_sum(src, seg, n):
    out = torch.zeros((n,) + src.shape[1:], dtype=src.dtype)
    return out.index_add_(0, seg, src)

def _pad(x, pw):
    flat = tuple((v for pair in reversed(pw) for v in pair))
    return torch.nn.functional.pad(x, flat)
kernel_name = 'adaLN_cond__sliding_block__glu_gated_glu__prompt'

def setup_inputs():

    _w = lambda a: (lambda t: t.to(torch.bfloat16) if t.is_floating_point() else t)(torch.as_tensor(a))

    def _A_setup():
        B, S, D = (1, 2048, 512)
        return {'x': _w((lambda *s: torch.randn(*s, dtype=torch.bfloat16) * 0.05)(B, S, D)), 'wqkv': _w((lambda *s: torch.randn(*s, dtype=torch.bfloat16) * 0.05)(D, 3 * D)), 'wo': _w((lambda *s: torch.randn(*s, dtype=torch.bfloat16) * 0.05)(D, D))}
    _A_in = _A_setup()

    def _B_setup():
        B, S, D, F = (1, 2048, 512, 1376)
        return {'x': _w((lambda *s: torch.randn(*s, dtype=torch.bfloat16) * 0.05)(B, S, D)), 'w_gate': _w((lambda *s: torch.randn(*s, dtype=torch.bfloat16) * 0.05)(D, F)), 'w_up': _w((lambda *s: torch.randn(*s, dtype=torch.bfloat16) * 0.05)(D, F)), 'w_down': _w((lambda *s: torch.randn(*s, dtype=torch.bfloat16) * 0.05)(F, D))}
    _B_in = _B_setup()
    return {'A_x': _A_in['x'], 'A_wqkv': _A_in['wqkv'], 'A_wo': _A_in['wo'], 'B_x': _B_in['x'], 'B_w_gate': _B_in['w_gate'], 'B_w_up': _B_in['w_up'], 'B_w_down': _B_in['w_down'], 'c': _w((lambda *s: torch.randn(*s, dtype=torch.bfloat16) * 0.1)(1, 512) * 8.0), 'w_mod': _w((lambda *s: torch.randn(*s, dtype=torch.bfloat16) * 0.1)(512, 6 * 512) * 512 ** (-0.5) * 8.0)}

def reference(A_x, A_wqkv, A_wo, B_x, B_w_gate, B_w_up, B_w_down, c, w_mod):

    def _A_ref(x, wqkv, wo):
        B, S, D = x.shape
        H = 32
        Dh = D // H
        W = 256
        qkv = (lambda x, *d: x.permute(*d))((x @ wqkv).reshape(B, S, 3, H, Dh), 2, 0, 3, 1, 4)
        q, k, v = (qkv[0], qkv[1], qkv[2])
        scores = torch.einsum('bhqd,bhkd->bhqk', q, k) * Dh ** (-0.5)
        idx = torch.arange(S)
        mask = (idx[:, None] - idx[None, :] >= 0) & (idx[:, None] - idx[None, :] < W)
        scores = torch.where(mask[None, None], scores, -1000000000.0)
        p = _softmax(scores, axis=-1)
        o = torch.einsum('bhqk,bhkd->bhqd', p, v)
        return (lambda x, *d: x.permute(*d))(o, 0, 2, 1, 3).reshape(B, S, D) @ wo

    def _B_ref(x, w_gate, w_up, w_down):
        g = torch.einsum('bsd,df->bsf', x, w_gate)
        u = torch.einsum('bsd,df->bsf', x, w_up)
        h = _sigmoid(g) * u
        return torch.einsum('bsf,fd->bsd', h, w_down)
    x = A_x
    mod = (_silu(c) @ w_mod).reshape(c.shape[0], 6, 1, -1)
    sa, ca, ga, sb, cb, gb = (mod[:, 0].clone(), mod[:, 1].clone(), mod[:, 2].clone(), mod[:, 3].clone(), mod[:, 4].clone(), mod[:, 5].clone())
    h = _layernorm(x, axis=-1) * (1 + ca) + sa
    x = x + ga * _A_ref(h, A_wqkv, A_wo)
    h = _layernorm(x, axis=-1) * (1 + cb) + sb
    x = x + gb * _B_ref(h, B_w_gate, B_w_up, B_w_down)
    return x
```

```asm
; @launch grid=(256,1,1) block=(512,1,1) lds=163840
.amdgcn_target "amdgcn-amd-amdhsa--gfx950"
.text
.globl adaLN_cond__sliding_block__glu_gated_glu__prompt_kernel
.p2align 8
.type adaLN_cond__sliding_block__glu_gated_glu__prompt_kernel,@function
adaLN_cond__sliding_block__glu_gated_glu__prompt_kernel:
s_cmp_ge_u32 s2, 256
s_cbranch_scc1 Lend
s_load_dwordx16 s[64:79], s[0:1], 0
s_load_dwordx8 s[80:87], s[0:1], 64
v_lshrrev_b32 v1, 6, v0
s_nop 0
v_readfirstlane_b32 s46, v1
v_and_b32 v0, 63, v0
v_lshlrev_b32 v1, 4, v0
s_and_b32 s61, s2, 7
s_lshr_b32 s60, s2, 3
s_lshr_b32 s49, s61, 1
s_and_b32 s50, s60, 3
s_lshl_b32 s44, s49, 2
s_lshl_b32 s51, s50, 0
s_add_u32 s44, s44, s51
s_and_b32 s49, s61, 1
s_lshr_b32 s57, s60, 2
s_and_b32 s62, s46, 3
s_lshr_b32 s56, s46, 2
s_lshl_b32 s45, s49, 3
s_lshl_b32 s51, s57, 0
s_add_u32 s45, s45, s51
s_lshl_b32 s48, s44, 2
s_lshl_b32 s51, s62, 0
s_add_u32 s48, s48, s51
s_and_b32 s49, s46, 1
s_lshl_b32 s55, s61, 3
s_lshl_b32 s51, s50, 1
s_add_u32 s55, s55, s51
s_lshl_b32 s51, s49, 0
s_add_u32 s55, s55, s51
s_lshl_b32 s63, s61, 5
s_lshl_b32 s51, s60, 0
s_add_u32 s63, s63, s51
s_mov_b32 s53, 0x3f803f80
s_mov_b32 s54, 0xffff0000
v_lshrrev_b32 v6, 5, v0
v_lshlrev_b32 v2, 9, v6
v_bfe_u32 v6, v0, 2, 2
v_lshl_add_u32 v2, v6, 6, v2
v_bfe_u32 v6, v0, 4, 1
v_lshl_add_u32 v2, v6, 5, v2
v_and_b32 v6, 3, v0
v_lshl_add_u32 v2, v6, 3, v2
s_waitcnt lgkmcnt(0)
s_lshr_b32 s1, s46, 1
s_mov_b32 s32, s86
s_and_b32 s33, s87, 0xffff
s_mov_b32 s34, 16777216
s_mov_b32 s35, 0x20000
s_mov_b32 s36, s78
s_and_b32 s37, s79, 0xffff
s_mov_b32 s38, 1024
s_mov_b32 s39, 0x20000
s_mov_b32 s40, s80
s_and_b32 s41, s81, 0xffff
s_mov_b32 s42, 3145728
s_mov_b32 s43, 0x20000
v_mov_b32 v6, 0
buffer_load_dword v24, v6, s[32:35], 0 offen sc1
s_lshl_b32 s49, s46, 6
v_add_u32 v6, s49, v0
v_mul_u32_u24 v149, 6144, v6
v_lshlrev_b32 v6, 1, v6
s_lshl_b32 s50, s63, 3
buffer_load_ushort v148, v6, s[36:39], 0 offen
buffer_load_dwordx2 v[40:41], v149, s[40:43], s50 offen
s_mov_b32 s4, s64
s_and_b32 s5, s65, 0xffff
s_mov_b32 s6, 2097152
s_mov_b32 s7, 0x20000
s_mov_b32 s8, s66
s_and_b32 s9, s67, 0xffff
s_mov_b32 s10, 1572864
s_mov_b32 s11, 0x20000
s_mov_b32 s12, s68
s_and_b32 s13, s69, 0xffff
s_mov_b32 s14, 524288
s_mov_b32 s15, 0x20000
s_mov_b32 s16, s72
s_and_b32 s17, s73, 0xffff
s_mov_b32 s18, 1409024
s_mov_b32 s19, 0x20000
s_mov_b32 s20, s74
s_and_b32 s21, s75, 0xffff
s_mov_b32 s22, 1409024
s_mov_b32 s23, 0x20000
s_mov_b32 s24, s76
s_and_b32 s25, s77, 0xffff
s_mov_b32 s26, 1409024
s_mov_b32 s27, 0x20000
s_mov_b32 s28, s82
s_and_b32 s29, s83, 0xffff
s_mov_b32 s30, 2097152
s_mov_b32 s31, 0x20000
s_cmp_lt_u32 s46, 4
s_cbranch_scc1 Lpr
s_setprio 1
Lpr:
v_lshrrev_b32 v6, 4, v0
v_add_u32 v6, 0, v6
v_and_b32 v7, 7, v0
v_xor_b32 v6, v6, v7
v_lshrrev_b32 v7, 3, v0
v_lshlrev_b32 v7, 10, v7
v_lshl_add_u32 v56, v6, 4, v7
v_lshrrev_b32 v6, 4, v0
v_add_u32 v6, 4, v6
v_and_b32 v7, 7, v0
v_xor_b32 v6, v6, v7
v_lshrrev_b32 v7, 3, v0
v_lshlrev_b32 v7, 10, v7
v_lshl_add_u32 v57, v6, 4, v7
s_lshl_b32 s59, s46, 13
s_add_u32 s59, s59, 98304
s_lshl_b32 s90, s48, 15
s_lshl_b32 s51, s56, 9
s_add_u32 s90, s90, s51
s_add_u32 m0, s59, 0
s_add_u32 s49, s90, 0
buffer_load_dwordx4 v56, s[4:7], s49 offen lds
s_add_u32 m0, s59, 1024
s_add_u32 s49, s90, 8192
buffer_load_dwordx4 v57, s[4:7], s49 offen lds
s_add_u32 m0, s59, 2048
s_add_u32 s49, s90, 16384
buffer_load_dwordx4 v56, s[4:7], s49 offen lds
s_add_u32 m0, s59, 3072
s_add_u32 s49, s90, 24576
buffer_load_dwordx4 v57, s[4:7], s49 offen lds
s_add_u32 m0, s59, 4096
s_add_u32 s49, s90, 128
buffer_load_dwordx4 v56, s[4:7], s49 offen lds
s_add_u32 m0, s59, 5120
s_add_u32 s49, s90, 8320
buffer_load_dwordx4 v57, s[4:7], s49 offen lds
s_add_u32 m0, s59, 6144
s_add_u32 s49, s90, 16512
buffer_load_dwordx4 v56, s[4:7], s49 offen lds
s_add_u32 m0, s59, 7168
s_add_u32 s49, s90, 24704
buffer_load_dwordx4 v57, s[4:7], s49 offen lds
s_cmp_lt_u32 s46, 1
s_cbranch_scc1 Lc1
s_cmp_ge_u32 s46, 2
s_cbranch_scc1 Lc1
s_lshr_b32 s50, s61, 1
s_lshl_b32 s49, s50, 19
s_lshl_b32 s51, s60, 14
s_add_u32 s49, s49, s51
s_lshl_b32 s51, s46, 8
s_add_u32 s49, s49, s51
v_lshrrev_b32 v6, 2, v0
v_lshlrev_b32 v6, 10, v6
v_and_b32 v7, 1, v0
v_lshl_add_u32 v6, v7, 7, v6
v_bfe_u32 v7, v0, 1, 1
v_lshl_add_u32 v6, v7, 9, v6
buffer_load_dword v23, v6, s[4:7], s49 offen
Lc1:
s_cmp_lt_u32 s46, 2
s_cbranch_scc1 Lc2
s_cmp_ge_u32 s46, 5
s_cbranch_scc1 Lc2
s_and_b32 s50, s61, 1
s_sub_u32 s58, s46, 2
s_mul_i32 s49, s60, 49152
s_lshl_b32 s51, s50, 9
s_add_u32 s49, s49, s51
s_lshl_b32 s51, s58, 10
s_add_u32 s49, s49, s51
v_lshrrev_b32 v6, 2, v0
v_mul_u32_u24 v6, 3072, v6
v_and_b32 v7, 3, v0
v_lshl_add_u32 v6, v7, 7, v6
buffer_load_dword v23, v6, s[8:11], s49 offen
Lc2:
v_lshrrev_b32 v6, 5, v0
v_add_u32 v6, 0, v6
v_bfe_u32 v7, v0, 1, 3
v_xor_b32 v6, v6, v7
v_and_b32 v7, 31, v0
v_lshlrev_b32 v7, 7, v7
v_lshl_add_u32 v6, v6, 4, v7
v_add_u32 v58, s59, v6
v_lshrrev_b32 v6, 5, v0
v_add_u32 v6, 2, v6
v_bfe_u32 v7, v0, 1, 3
v_xor_b32 v6, v6, v7
v_and_b32 v7, 31, v0
v_lshlrev_b32 v7, 7, v7
v_lshl_add_u32 v6, v6, 4, v7
v_add_u32 v59, s59, v6
v_lshrrev_b32 v6, 5, v0
v_add_u32 v6, 4, v6
v_bfe_u32 v7, v0, 1, 3
v_xor_b32 v6, v6, v7
v_and_b32 v7, 31, v0
v_lshlrev_b32 v7, 7, v7
v_lshl_add_u32 v6, v6, 4, v7
v_add_u32 v60, s59, v6
v_lshrrev_b32 v6, 5, v0
v_add_u32 v6, 6, v6
v_bfe_u32 v7, v0, 1, 3
v_xor_b32 v6, v6, v7
v_and_b32 v7, 31, v0
v_lshlrev_b32 v7, 7, v7
v_lshl_add_u32 v6, v6, 4, v7
v_add_u32 v61, s59, v6
v_and_b32 v6, 0x1f0, v1
v_lshlrev_b32 v6, 6, v6
v_lshrrev_b32 v7, 9, v1
v_lshl_add_u32 v62, v7, 4, v6
s_lshl_b32 s3, s55, 15
s_lshl_b32 s51, s57, 7
s_add_u32 s3, s3, s51
s_lshl_b32 s51, s1, 5
s_add_u32 s3, s3, s51
buffer_load_dwordx4 v[8:11], v62, s[4:7], s3 offen
v_lshrrev_b32 v6, 6, v1
v_mul_u32_u24 v6, 3072, v6
v_and_b32 v7, 48, v1
v_add_u32 v5, v6, v7
s_mul_i32 s92, s62, 98304
s_mul_i32 s51, s56, 393216
s_add_u32 s92, s92, s51
s_lshl_b32 s51, s45, 6
s_add_u32 s92, s92, s51
s_mul_i32 s91, s62, 6144
s_mul_i32 s51, s56, 24576
s_add_u32 s91, s91, s51
s_waitcnt vmcnt(9)
v_readfirstlane_b32 s47, v24
v_lshlrev_b32 v148, 16, v148
v_mul_f32 v6, 0xbfb8aa3b, v148
v_exp_f32 v6, v6
s_nop 0
v_add_f32 v6, 1.0, v6
v_rcp_f32 v6, v6
s_nop 0
v_mul_f32 v6, v6, v148
v_cvt_pk_bf16_f32 v6, v6, v6
v_and_b32 v148, s54, v6
s_mul_i32 s47, s47, 1664525
s_add_u32 s47, s47, 1013904223
v_lshlrev_b32 v6, 16, v40
v_and_b32 v7, s54, v40
v_mul_f32 v24, v6, v148
v_mul_f32 v25, v7, v148
v_lshlrev_b32 v6, 16, v41
v_and_b32 v7, s54, v41
v_mul_f32 v26, v6, v148
v_mul_f32 v27, v7, v148
v_add_f32_dpp v24, v24, v24 row_shr:1 bound_ctrl:0
v_add_f32_dpp v25, v25, v25 row_shr:1 bound_ctrl:0
v_add_f32_dpp v26, v26, v26 row_shr:1 bound_ctrl:0
v_add_f32_dpp v27, v27, v27 row_shr:1 bound_ctrl:0
v_add_f32_dpp v24, v24, v24 row_shr:2 bound_ctrl:0
v_add_f32_dpp v25, v25, v25 row_shr:2 bound_ctrl:0
v_add_f32_dpp v26, v26, v26 row_shr:2 bound_ctrl:0
v_add_f32_dpp v27, v27, v27 row_shr:2 bound_ctrl:0
v_add_f32_dpp v24, v24, v24 row_shr:4 bound_ctrl:0
v_add_f32_dpp v25, v25, v25 row_shr:4 bound_ctrl:0
v_add_f32_dpp v26, v26, v26 row_shr:4 bound_ctrl:0
v_add_f32_dpp v27, v27, v27 row_shr:4 bound_ctrl:0
v_add_f32_dpp v24, v24, v24 row_shr:8 bound_ctrl:0
v_add_f32_dpp v25, v25, v25 row_shr:8 bound_ctrl:0
v_add_f32_dpp v26, v26, v26 row_shr:8 bound_ctrl:0
v_add_f32_dpp v27, v27, v27 row_shr:8 bound_ctrl:0
v_add_f32_dpp v24, v24, v24 row_bcast:15 row_mask:0xa
v_add_f32_dpp v25, v25, v25 row_bcast:15 row_mask:0xa
v_add_f32_dpp v26, v26, v26 row_bcast:15 row_mask:0xa
v_add_f32_dpp v27, v27, v27 row_bcast:15 row_mask:0xa
v_add_f32_dpp v24, v24, v24 row_bcast:31 row_mask:0xc
v_add_f32_dpp v25, v25, v25 row_bcast:31 row_mask:0xc
v_add_f32_dpp v26, v26, v26 row_bcast:31 row_mask:0xc
v_add_f32_dpp v27, v27, v27 row_bcast:31 row_mask:0xc
s_mul_i32 s49, s46, 32
s_add_u32 s49, s49, 49152
v_mov_b32 v6, s49
s_mov_b32 exec_lo, 0
s_mov_b32 exec_hi, 0x80000000
ds_write_b128 v6, v[24:27] offset:0
s_mov_b64 exec, -1
s_waitcnt lgkmcnt(0)
s_barrier
s_lshl_b32 s58, s63, 4
s_add_u32 s58, s58, 4096
s_cmp_lg_u32 s46, 0
s_cbranch_scc1 Lnopub
v_and_b32 v6, 16, v1
v_add_u32 v7, 49152, v6
ds_read_b128 v[64:67], v7 offset:0
ds_read_b128 v[68:71], v7 offset:32
ds_read_b128 v[72:75], v7 offset:64
ds_read_b128 v[76:79], v7 offset:96
ds_read_b128 v[80:83], v7 offset:128
ds_read_b128 v[84:87], v7 offset:160
ds_read_b128 v[88:91], v7 offset:192
ds_read_b128 v[92:95], v7 offset:224
s_waitcnt lgkmcnt(0)
v_add_f32 v64, v64, v80
v_add_f32 v65, v65, v81
v_add_f32 v66, v66, v82
v_add_f32 v67, v67, v83
v_add_f32 v68, v68, v84
v_add_f32 v69, v69, v85
v_add_f32 v70, v70, v86
v_add_f32 v71, v71, v87
v_add_f32 v72, v72, v88
v_add_f32 v73, v73, v89
v_add_f32 v74, v74, v90
v_add_f32 v75, v75, v91
v_add_f32 v76, v76, v92
v_add_f32 v77, v77, v93
v_add_f32 v78, v78, v94
v_add_f32 v79, v79, v95
v_add_f32 v64, v64, v72
v_add_f32 v65, v65, v73
v_add_f32 v66, v66, v74
v_add_f32 v67, v67, v75
v_add_f32 v68, v68, v76
v_add_f32 v69, v69, v77
v_add_f32 v70, v70, v78
v_add_f32 v71, v71, v79
v_add_f32 v64, v64, v68
v_add_f32 v65, v65, v69
v_add_f32 v66, v66, v70
v_add_f32 v67, v67, v71
v_cvt_pk_bf16_f32 v64, v64, v65
v_cvt_pk_bf16_f32 v66, v66, v67
v_mov_b32 v65, s47
v_mov_b32 v67, s47
s_mov_b64 exec, 1
buffer_store_dwordx4 v[64:67], v6, s[32:35], s58 offen sc1
s_mov_b64 exec, -1
Lnopub:
v_mov_b32 v28, 0
v_mov_b32 v29, 0
v_mov_b32 v30, 0
v_mov_b32 v31, 0
s_waitcnt vmcnt(1)
ds_read_b128 v[192:195], v58 offset:0
ds_read_b128 v[196:199], v59 offset:0
ds_read_b128 v[200:203], v60 offset:0
ds_read_b128 v[204:207], v61 offset:0
ds_read_b128 v[208:211], v58 offset:4096
ds_read_b128 v[212:215], v59 offset:4096
ds_read_b128 v[216:219], v60 offset:4096
ds_read_b128 v[220:223], v61 offset:4096
s_waitcnt lgkmcnt(0)
s_add_u32 m0, s59, 0
s_add_u32 s49, s90, 256
buffer_load_dwordx4 v56, s[4:7], s49 offen lds
s_add_u32 m0, s59, 1024
s_add_u32 s49, s90, 8448
buffer_load_dwordx4 v57, s[4:7], s49 offen lds
s_add_u32 m0, s59, 2048
s_add_u32 s49, s90, 16640
buffer_load_dwordx4 v56, s[4:7], s49 offen lds
s_add_u32 m0, s59, 3072
s_add_u32 s49, s90, 24832
buffer_load_dwordx4 v57, s[4:7], s49 offen lds
s_add_u32 m0, s59, 4096
s_add_u32 s49, s90, 384
buffer_load_dwordx4 v56, s[4:7], s49 offen lds
s_add_u32 m0, s59, 5120
s_add_u32 s49, s90, 8576
buffer_load_dwordx4 v57, s[4:7], s49 offen lds
s_add_u32 m0, s59, 6144
s_add_u32 s49, s90, 16768
buffer_load_dwordx4 v56, s[4:7], s49 offen lds
s_add_u32 m0, s59, 7168
s_add_u32 s49, s90, 24960
buffer_load_dwordx4 v57, s[4:7], s49 offen lds
v_dot2_f32_bf16 v28, v192, s53, v28
v_dot2_f32_bf16 v30, v192, v192, v30
v_dot2_f32_bf16 v29, v193, s53, v29
v_dot2_f32_bf16 v31, v193, v193, v31
s_add_u32 m0, s91, 0
s_add_u32 s49, s92, 0
buffer_load_dwordx4 v5, s[8:11], s49 offen lds
v_dot2_f32_bf16 v28, v194, s53, v28
v_dot2_f32_bf16 v30, v194, v194, v30
v_dot2_f32_bf16 v29, v195, s53, v29
v_dot2_f32_bf16 v31, v195, v195, v31
s_add_u32 m0, s91, 1024
s_add_u32 s49, s92, 1024
buffer_load_dwordx4 v5, s[8:11], s49 offen lds
v_dot2_f32_bf16 v28, v196, s53, v28
v_dot2_f32_bf16 v30, v196, v196, v30
v_dot2_f32_bf16 v29, v197, s53, v29
v_dot2_f32_bf16 v31, v197, v197, v31
s_add_u32 m0, s91, 2048
s_add_u32 s49, s92, 2048
buffer_load_dwordx4 v5, s[8:11], s49 offen lds
v_dot2_f32_bf16 v28, v198, s53, v28
v_dot2_f32_bf16 v30, v198, v198, v30
v_dot2_f32_bf16 v29, v199, s53, v29
v_dot2_f32_bf16 v31, v199, v199, v31
s_add_u32 m0, s91, 3072
s_add_u32 s49, s92, 49152
buffer_load_dwordx4 v5, s[8:11], s49 offen lds
v_dot2_f32_bf16 v28, v200, s53, v28
v_dot2_f32_bf16 v30, v200, v200, v30
v_dot2_f32_bf16 v29, v201, s53, v29
v_dot2_f32_bf16 v31, v201, v201, v31
s_add_u32 m0, s91, 4096
s_add_u32 s49, s92, 50176
buffer_load_dwordx4 v5, s[8:11], s49 offen lds
v_dot2_f32_bf16 v28, v202, s53, v28
v_dot2_f32_bf16 v30, v202, v202, v30
v_dot2_f32_bf16 v29, v203, s53, v29
v_dot2_f32_bf16 v31, v203, v203, v31
s_add_u32 m0, s91, 5120
s_add_u32 s49, s92, 51200
buffer_load_dwordx4 v5, s[8:11], s49 offen lds
v_dot2_f32_bf16 v28, v204, s53, v28
v_dot2_f32_bf16 v30, v204, v204, v30
v_dot2_f32_bf16 v29, v205, s53, v29
v_dot2_f32_bf16 v31, v205, v205, v31
v_dot2_f32_bf16 v28, v206, s53, v28
v_dot2_f32_bf16 v30, v206, v206, v30
v_dot2_f32_bf16 v29, v207, s53, v29
v_dot2_f32_bf16 v31, v207, v207, v31
v_dot2_f32_bf16 v28, v208, s53, v28
v_dot2_f32_bf16 v30, v208, v208, v30
v_dot2_f32_bf16 v29, v209, s53, v29
v_dot2_f32_bf16 v31, v209, v209, v31
v_dot2_f32_bf16 v28, v210, s53, v28
v_dot2_f32_bf16 v30, v210, v210, v30
v_dot2_f32_bf16 v29, v211, s53, v29
v_dot2_f32_bf16 v31, v211, v211, v31
v_dot2_f32_bf16 v28, v212, s53, v28
v_dot2_f32_bf16 v30, v212, v212, v30
v_dot2_f32_bf16 v29, v213, s53, v29
v_dot2_f32_bf16 v31, v213, v213, v31
v_dot2_f32_bf16 v28, v214, s53, v28
v_dot2_f32_bf16 v30, v214, v214, v30
v_dot2_f32_bf16 v29, v215, s53, v29
v_dot2_f32_bf16 v31, v215, v215, v31
v_dot2_f32_bf16 v28, v216, s53, v28
v_dot2_f32_bf16 v30, v216, v216, v30
v_dot2_f32_bf16 v29, v217, s53, v29
v_dot2_f32_bf16 v31, v217, v217, v31
v_dot2_f32_bf16 v28, v218, s53, v28
v_dot2_f32_bf16 v30, v218, v218, v30
v_dot2_f32_bf16 v29, v219, s53, v29
v_dot2_f32_bf16 v31, v219, v219, v31
v_dot2_f32_bf16 v28, v220, s53, v28
v_dot2_f32_bf16 v30, v220, v220, v30
v_dot2_f32_bf16 v29, v221, s53, v29
v_dot2_f32_bf16 v31, v221, v221, v31
v_dot2_f32_bf16 v28, v222, s53, v28
v_dot2_f32_bf16 v30, v222, v222, v30
v_dot2_f32_bf16 v29, v223, s53, v29
v_dot2_f32_bf16 v31, v223, v223, v31
s_waitcnt vmcnt(6)
ds_read_b128 v[224:227], v58 offset:0
ds_read_b128 v[228:231], v59 offset:0
ds_read_b128 v[232:235], v60 offset:0
ds_read_b128 v[236:239], v61 offset:0
ds_read_b128 v[240:243], v58 offset:4096
ds_read_b128 v[244:247], v59 offset:4096
ds_read_b128 v[248:251], v60 offset:4096
ds_read_b128 v[252:255], v61 offset:4096
s_waitcnt lgkmcnt(0)
v_dot2_f32_bf16 v28, v224, s53, v28
v_dot2_f32_bf16 v30, v224, v224, v30
v_dot2_f32_bf16 v29, v225, s53, v29
v_dot2_f32_bf16 v31, v225, v225, v31
s_add_u32 m0, s91, 49152
s_add_u32 s49, s92, 786432
buffer_load_dwordx4 v5, s[8:11], s49 offen lds
v_dot2_f32_bf16 v28, v226, s53, v28
v_dot2_f32_bf16 v30, v226, v226, v30
v_dot2_f32_bf16 v29, v227, s53, v29
v_dot2_f32_bf16 v31, v227, v227, v31
s_add_u32 m0, s91, 50176
s_add_u32 s49, s92, 787456
buffer_load_dwordx4 v5, s[8:11], s49 offen lds
v_dot2_f32_bf16 v28, v228, s53, v28
v_dot2_f32_bf16 v30, v228, v228, v30
v_dot2_f32_bf16 v29, v229, s53, v29
v_dot2_f32_bf16 v31, v229, v229, v31
s_add_u32 m0, s91, 51200
s_add_u32 s49, s92, 788480
buffer_load_dwordx4 v5, s[8:11], s49 offen lds
v_dot2_f32_bf16 v28, v230, s53, v28
v_dot2_f32_bf16 v30, v230, v230, v30
v_dot2_f32_bf16 v29, v231, s53, v29
v_dot2_f32_bf16 v31, v231, v231, v31
s_add_u32 m0, s91, 52224
s_add_u32 s49, s92, 835584
buffer_load_dwordx4 v5, s[8:11], s49 offen lds
v_dot2_f32_bf16 v28, v232, s53, v28
v_dot2_f32_bf16 v30, v232, v232, v30
v_dot2_f32_bf16 v29, v233, s53, v29
v_dot2_f32_bf16 v31, v233, v233, v31
s_add_u32 m0, s91, 53248
s_add_u32 s49, s92, 836608
buffer_load_dwordx4 v5, s[8:11], s49 offen lds
v_dot2_f32_bf16 v28, v234, s53, v28
v_dot2_f32_bf16 v30, v234, v234, v30
v_dot2_f32_bf16 v29, v235, s53, v29
v_dot2_f32_bf16 v31, v235, v235, v31
s_add_u32 m0, s91, 54272
s_add_u32 s49, s92, 837632
buffer_load_dwordx4 v5, s[8:11], s49 offen lds
v_dot2_f32_bf16 v28, v236, s53, v28
v_dot2_f32_bf16 v30, v236, v236, v30
v_dot2_f32_bf16 v29, v237, s53, v29
v_dot2_f32_bf16 v31, v237, v237, v31
v_dot2_f32_bf16 v28, v238, s53, v28
v_dot2_f32_bf16 v30, v238, v238, v30
v_dot2_f32_bf16 v29, v239, s53, v29
v_dot2_f32_bf16 v31, v239, v239, v31
v_dot2_f32_bf16 v28, v240, s53, v28
v_dot2_f32_bf16 v30, v240, v240, v30
v_dot2_f32_bf16 v29, v241, s53, v29
v_dot2_f32_bf16 v31, v241, v241, v31
v_dot2_f32_bf16 v28, v242, s53, v28
v_dot2_f32_bf16 v30, v242, v242, v30
v_dot2_f32_bf16 v29, v243, s53, v29
v_dot2_f32_bf16 v31, v243, v243, v31
v_dot2_f32_bf16 v28, v244, s53, v28
v_dot2_f32_bf16 v30, v244, v244, v30
v_dot2_f32_bf16 v29, v245, s53, v29
v_dot2_f32_bf16 v31, v245, v245, v31
v_dot2_f32_bf16 v28, v246, s53, v28
v_dot2_f32_bf16 v30, v246, v246, v30
v_dot2_f32_bf16 v29, v247, s53, v29
v_dot2_f32_bf16 v31, v247, v247, v31
v_dot2_f32_bf16 v28, v248, s53, v28
v_dot2_f32_bf16 v30, v248, v248, v30
v_dot2_f32_bf16 v29, v249, s53, v29
v_dot2_f32_bf16 v31, v249, v249, v31
v_dot2_f32_bf16 v28, v250, s53, v28
v_dot2_f32_bf16 v30, v250, v250, v30
v_dot2_f32_bf16 v29, v251, s53, v29
v_dot2_f32_bf16 v31, v251, v251, v31
v_dot2_f32_bf16 v28, v252, s53, v28
v_dot2_f32_bf16 v30, v252, v252, v30
v_dot2_f32_bf16 v29, v253, s53, v29
v_dot2_f32_bf16 v31, v253, v253, v31
v_dot2_f32_bf16 v28, v254, s53, v28
v_dot2_f32_bf16 v30, v254, v254, v30
v_dot2_f32_bf16 v29, v255, s53, v29
v_dot2_f32_bf16 v31, v255, v255, v31
s_nop 2
v_add_f32 v28, v28, v29
v_add_f32 v29, v30, v31
v_mov_b32 v30, v28
s_nop 1
v_permlane32_swap_b32 v28, v30
v_add_f32 v28, v28, v30
v_mov_b32 v30, v29
s_nop 1
v_permlane32_swap_b32 v29, v30
v_add_f32 v29, v29, v30
v_lshrrev_b32 v6, 1, v1
v_and_b32 v6, 0xf8, v6
s_add_u32 s49, s59, 6144
v_add_u32 v16, s49, v6
s_xor_b32 s49, s46, 4
s_lshl_b32 s50, s49, 13
s_add_u32 s50, s50, 104448
v_add_u32 v17, s50, v6
ds_write_b64 v16, v[28:29] offset:0
s_cmp_lg_u32 s46, 0
s_cbranch_scc1 Lnon
s_mov_b32 s50, 4096
v_lshlrev_b32 v26, 1, v1
s_mov_b32 s52, 400000
Lp3:
buffer_load_dwordx4 v[32:35], v26, s[32:35], s50 offen offset:0 sc1
buffer_load_dwordx4 v[36:39], v26, s[32:35], s50 offen offset:16 sc1
buffer_load_dwordx4 v[40:43], v26, s[32:35], s50 offen offset:2048 sc1
buffer_load_dwordx4 v[44:47], v26, s[32:35], s50 offen offset:2064 sc1
s_waitcnt vmcnt(0)
v_cmp_ne_u32 vcc, s47, v33
v_cmp_ne_u32 s[98:99], s47, v35
s_nop 1
s_or_b64 vcc, vcc, s[98:99]
v_cmp_ne_u32 s[98:99], s47, v37
s_nop 1
s_or_b64 vcc, vcc, s[98:99]
v_cmp_ne_u32 s[98:99], s47, v39
s_nop 1
s_or_b64 vcc, vcc, s[98:99]
v_cmp_ne_u32 s[98:99], s47, v41
s_nop 1
s_or_b64 vcc, vcc, s[98:99]
v_cmp_ne_u32 s[98:99], s47, v43
s_nop 1
s_or_b64 vcc, vcc, s[98:99]
v_cmp_ne_u32 s[98:99], s47, v45
s_nop 1
s_or_b64 vcc, vcc, s[98:99]
v_cmp_ne_u32 s[98:99], s47, v47
s_nop 1
s_or_b64 vcc, vcc, s[98:99]
s_nop 0
s_cbranch_vccz Ld4
s_sub_u32 s52, s52, 1
s_cmp_lg_u32 s52, 0
s_cbranch_scc1 Lp3
Ld4:
v_lshlrev_b32 v56, 16, v32
v_and_b32 v57, s54, v32
v_lshlrev_b32 v48, 16, v40
v_and_b32 v49, s54, v40
v_lshlrev_b32 v58, 16, v34
v_and_b32 v59, s54, v34
v_lshlrev_b32 v50, 16, v42
v_and_b32 v51, s54, v42
v_lshlrev_b32 v60, 16, v36
v_and_b32 v61, s54, v36
v_lshlrev_b32 v52, 16, v44
v_and_b32 v53, s54, v44
v_lshlrev_b32 v62, 16, v38
v_and_b32 v63, s54, v38
v_lshlrev_b32 v54, 16, v46
v_and_b32 v55, s54, v46
v_add_f32 v48, 1.0, v48
v_add_f32 v49, 1.0, v49
v_cvt_pk_bf16_f32 v49, v48, v49
v_lshlrev_b32 v48, 16, v49
v_and_b32 v49, s54, v49
v_add_f32 v50, 1.0, v50
v_add_f32 v51, 1.0, v51
v_cvt_pk_bf16_f32 v51, v50, v51
v_lshlrev_b32 v50, 16, v51
v_and_b32 v51, s54, v51
v_add_f32 v52, 1.0, v52
v_add_f32 v53, 1.0, v53
v_cvt_pk_bf16_f32 v53, v52, v53
v_lshlrev_b32 v52, 16, v53
v_and_b32 v53, s54, v53
v_add_f32 v54, 1.0, v54
v_add_f32 v55, 1.0, v55
v_cvt_pk_bf16_f32 v55, v54, v55
v_lshlrev_b32 v54, 16, v55
v_and_b32 v55, s54, v55
v_lshlrev_b32 v6, 2, v1
v_add_u32 v6, 98304, v6
ds_write_b128 v6, v[48:51] offset:0
ds_write_b128 v6, v[52:55] offset:16
ds_write_b128 v6, v[56:59] offset:32
ds_write_b128 v6, v[60:63] offset:48
s_cmp_lg_u32 s2, 0
s_cbranch_scc1 Lnon
v_mov_b32 v6, s47
v_mov_b32 v7, 0
buffer_store_dword v6, v7, s[32:35], 0 offen sc1
Lnon:
s_waitcnt vmcnt(0)
s_waitcnt lgkmcnt(0)
s_barrier
ds_read_b64 v[30:31], v17 offset:0
s_waitcnt lgkmcnt(0)
v_add_f32 v28, v28, v30
v_add_f32 v29, v29, v31
v_mul_f32 v28, 0x3b000000, v28
v_mul_f32 v29, 0x3b000000, v29
v_fma_f32 v29, -v28, v28, v29
v_max_f32 v29, 0, v29
v_add_f32 v29, 0x3727c5ac, v29
v_rsq_f32 v92, v29
s_nop 0
v_mul_f32 v93, v28, v92
v_sub_f32 v93, 0, v93
s_lshl_b32 s49, s56, 11
s_add_u32 s49, s49, 98304
v_lshrrev_b32 v16, 9, v1
v_lshlrev_b32 v16, 6, v16
v_add_u32 v16, s49, v16
s_mul_i32 s49, s56, 49152
v_add_u32 v3, s49, v2
ds_read_b128 v[24:27], v16 offset:0
ds_read_b128 v[28:31], v16 offset:16
ds_read_b128 v[32:35], v16 offset:32
ds_read_b128 v[36:39], v16 offset:48
ds_read_b128 v[40:43], v16 offset:128
ds_read_b128 v[44:47], v16 offset:144
ds_read_b128 v[48:51], v16 offset:160
ds_read_b128 v[52:55], v16 offset:176
ds_read_b64_tr_b16 v[60:61], v3 offset:1024
ds_read_b64_tr_b16 v[62:63], v3 offset:1280
ds_read_b64_tr_b16 v[64:65], v3 offset:2048
ds_read_b64_tr_b16 v[66:67], v3 offset:2304
s_waitcnt lgkmcnt(0)
v_lshlrev_b32 v88, 16, v192
v_and_b32 v89, s54, v192
v_fma_f32 v88, v88, v92, v93
v_fma_f32 v89, v89, v92, v93
v_fmac_f32 v32, v88, v24
v_fmac_f32 v33, v89, v25
v_cvt_pk_bf16_f32 v192, v32, v33
v_lshlrev_b32 v90, 16, v193
v_and_b32 v91, s54, v193
v_fma_f32 v90, v90, v92, v93
v_fma_f32 v91, v91, v92, v93
v_fmac_f32 v34, v90, v26
v_fmac_f32 v35, v91, v27
v_cvt_pk_bf16_f32 v193, v34, v35
v_lshlrev_b32 v88, 16, v194
v_and_b32 v89, s54, v194
v_fma_f32 v88, v88, v92, v93
v_fma_f32 v89, v89, v92, v93
v_fmac_f32 v36, v88, v28
v_fmac_f32 v37, v89, v29
v_cvt_pk_bf16_f32 v194, v36, v37
v_lshlrev_b32 v90, 16, v195
v_and_b32 v91, s54, v195
v_fma_f32 v90, v90, v92, v93
v_fma_f32 v91, v91, v92, v93
v_fmac_f32 v38, v90, v30
v_fmac_f32 v39, v91, v31
v_cvt_pk_bf16_f32 v195, v38, v39
s_waitcnt lgkmcnt(0)
s_nop 0
v_mfma_f32_32x32x16_bf16 v[112:127], v[60:63], v[192:195], 0
ds_read_b64_tr_b16 v[72:73], v3 offset:4096
ds_read_b64_tr_b16 v[74:75], v3 offset:4352
ds_read_b64_tr_b16 v[76:77], v3 offset:5120
ds_read_b64_tr_b16 v[78:79], v3 offset:5376
ds_read_b128 v[24:27], v16 offset:256
ds_read_b128 v[28:31], v16 offset:272
ds_read_b128 v[32:35], v16 offset:288
ds_read_b128 v[36:39], v16 offset:304
v_lshlrev_b32 v88, 16, v196
v_and_b32 v89, s54, v196
v_fma_f32 v88, v88, v92, v93
v_fma_f32 v89, v89, v92, v93
v_fmac_f32 v48, v88, v40
v_fmac_f32 v49, v89, v41
v_cvt_pk_bf16_f32 v196, v48, v49
v_lshlrev_b32 v90, 16, v197
v_and_b32 v91, s54, v197
v_fma_f32 v90, v90, v92, v93
v_fma_f32 v91, v91, v92, v93
v_mfma_f32_32x32x16_bf16 v[128:143], v[192:195], v[64:67], 0
v_fmac_f32 v50, v90, v42
v_fmac_f32 v51, v91, v43
v_cvt_pk_bf16_f32 v197, v50, v51
v_lshlrev_b32 v88, 16, v198
v_and_b32 v89, s54, v198
v_fma_f32 v88, v88, v92, v93
v_fma_f32 v89, v89, v92, v93
v_fmac_f32 v52, v88, v44
v_fmac_f32 v53, v89, v45
v_cvt_pk_bf16_f32 v198, v52, v53
v_lshlrev_b32 v90, 16, v199
v_and_b32 v91, s54, v199
v_fma_f32 v90, v90, v92, v93
v_fma_f32 v91, v91, v92, v93
v_fmac_f32 v54, v90, v46
v_fmac_f32 v55, v91, v47
v_cvt_pk_bf16_f32 v199, v54, v55
s_waitcnt lgkmcnt(0)
s_nop 0
v_mfma_f32_32x32x16_bf16 v[112:127], v[72:75], v[196:199], v[112:127]
ds_read_b64_tr_b16 v[60:61], v3 offset:7168
ds_read_b64_tr_b16 v[62:63], v3 offset:7424
ds_read_b64_tr_b16 v[64:65], v3 offset:8192
ds_read_b64_tr_b16 v[66:67], v3 offset:8448
ds_read_b128 v[40:43], v16 offset:384
ds_read_b128 v[44:47], v16 offset:400
ds_read_b128 v[48:51], v16 offset:416
ds_read_b128 v[52:55], v16 offset:432
v_lshlrev_b32 v88, 16, v200
v_and_b32 v89, s54, v200
v_fma_f32 v88, v88, v92, v93
v_fma_f32 v89, v89, v92, v93
v_fmac_f32 v32, v88, v24
v_fmac_f32 v33, v89, v25
v_cvt_pk_bf16_f32 v200, v32, v33
v_lshlrev_b32 v90, 16, v201
v_and_b32 v91, s54, v201
v_fma_f32 v90, v90, v92, v93
v_fma_f32 v91, v91, v92, v93
v_mfma_f32_32x32x16_bf16 v[128:143], v[196:199], v[76:79], v[128:143]
v_fmac_f32 v34, v90, v26
v_fmac_f32 v35, v91, v27
v_cvt_pk_bf16_f32 v201, v34, v35
v_lshlrev_b32 v88, 16, v202
v_and_b32 v89, s54, v202
v_fma_f32 v88, v88, v92, v93
v_fma_f32 v89, v89, v92, v93
v_fmac_f32 v36, v88, v28
v_fmac_f32 v37, v89, v29
v_cvt_pk_bf16_f32 v202, v36, v37
v_lshlrev_b32 v90, 16, v203
v_and_b32 v91, s54, v203
v_fma_f32 v90, v90, v92, v93
v_fma_f32 v91, v91, v92, v93
v_fmac_f32 v38, v90, v30
v_fmac_f32 v39, v91, v31
v_cvt_pk_bf16_f32 v203, v38, v39
s_lshl_b32 s50, s63, 4
s_add_u32 s50, s50, 2048
buffer_load_dwordx4 v[144:147], v149, s[40:43], s50 offen
v_and_b32 v6, 0xf0, v1
v_lshlrev_b32 v6, 3, v6
s_lshl_b32 s49, s60, 14
s_lshl_b32 s51, s46, 11
s_add_u32 s49, s49, s51
buffer_load_dword v23, v6, s[12:15], s49 offen
s_waitcnt lgkmcnt(0)
v_mfma_f32_32x32x16_bf16 v[112:127], v[60:63], v[200:203], v[112:127]
ds_read_b64_tr_b16 v[72:73], v3 offset:10240
ds_read_b64_tr_b16 v[74:75], v3 offset:10496
ds_read_b64_tr_b16 v[76:77], v3 offset:11264
ds_read_b64_tr_b16 v[78:79], v3 offset:11520
ds_read_b128 v[24:27], v16 offset:512
ds_read_b128 v[28:31], v16 offset:528
ds_read_b128 v[32:35], v16 offset:544
ds_read_b128 v[36:39], v16 offset:560
v_lshlrev_b32 v88, 16, v204
v_and_b32 v89, s54, v204
v_fma_f32 v88, v88, v92, v93
v_fma_f32 v89, v89, v92, v93
v_fmac_f32 v48, v88, v40
v_fmac_f32 v49, v89, v41
v_cvt_pk_bf16_f32 v204, v48, v49
v_lshlrev_b32 v90, 16, v205
v_and_b32 v91, s54, v205
v_fma_f32 v90, v90, v92, v93
v_fma_f32 v91, v91, v92, v93
v_mfma_f32_32x32x16_bf16 v[128:143], v[200:203], v[64:67], v[128:143]
v_fmac_f32 v50, v90, v42
v_fmac_f32 v51, v91, v43
v_cvt_pk_bf16_f32 v205, v50, v51
v_lshlrev_b32 v88, 16, v206
v_and_b32 v89, s54, v206
v_fma_f32 v88, v88, v92, v93
v_fma_f32 v89, v89, v92, v93
v_fmac_f32 v52, v88, v44
v_fmac_f32 v53, v89, v45
v_cvt_pk_bf16_f32 v206, v52, v53
v_lshlrev_b32 v90, 16, v207
v_and_b32 v91, s54, v207
v_fma_f32 v90, v90, v92, v93
v_fma_f32 v91, v91, v92, v93
v_fmac_f32 v54, v90, v46
v_fmac_f32 v55, v91, v47
v_cvt_pk_bf16_f32 v207, v54, v55
s_waitcnt lgkmcnt(0)
s_nop 0
v_mfma_f32_32x32x16_bf16 v[112:127], v[72:75], v[204:207], v[112:127]
ds_read_b64_tr_b16 v[60:61], v3 offset:13312
ds_read_b64_tr_b16 v[62:63], v3 offset:13568
ds_read_b64_tr_b16 v[64:65], v3 offset:14336
ds_read_b64_tr_b16 v[66:67], v3 offset:14592
ds_read_b128 v[40:43], v16 offset:640
ds_read_b128 v[44:47], v16 offset:656
ds_read_b128 v[48:51], v16 offset:672
ds_read_b128 v[52:55], v16 offset:688
v_lshlrev_b32 v88, 16, v208
v_and_b32 v89, s54, v208
v_fma_f32 v88, v88, v92, v93
v_fma_f32 v89, v89, v92, v93
v_fmac_f32 v32, v88, v24
v_fmac_f32 v33, v89, v25
v_cvt_pk_bf16_f32 v208, v32, v33
v_lshlrev_b32 v90, 16, v209
v_and_b32 v91, s54, v209
v_fma_f32 v90, v90, v92, v93
v_fma_f32 v91, v91, v92, v93
v_mfma_f32_32x32x16_bf16 v[128:143], v[204:207], v[76:79], v[128:143]
v_fmac_f32 v34, v90, v26
v_fmac_f32 v35, v91, v27
v_cvt_pk_bf16_f32 v209, v34, v35
v_lshlrev_b32 v88, 16, v210
v_and_b32 v89, s54, v210
v_fma_f32 v88, v88, v92, v93
v_fma_f32 v89, v89, v92, v93
v_fmac_f32 v36, v88, v28
v_fmac_f32 v37, v89, v29
v_cvt_pk_bf16_f32 v210, v36, v37
v_lshlrev_b32 v90, 16, v211
v_and_b32 v91, s54, v211
v_fma_f32 v90, v90, v92, v93
v_fma_f32 v91, v91, v92, v93
v_fmac_f32 v38, v90, v30
v_fmac_f32 v39, v91, v31
v_cvt_pk_bf16_f32 v211, v38, v39
s_waitcnt lgkmcnt(0)
s_nop 0
v_mfma_f32_32x32x16_bf16 v[112:127], v[60:63], v[208:211], v[112:127]
ds_read_b64_tr_b16 v[72:73], v3 offset:16384
ds_read_b64_tr_b16 v[74:75], v3 offset:16640
ds_read_b64_tr_b16 v[76:77], v3 offset:17408
ds_read_b64_tr_b16 v[78:79], v3 offset:17664
ds_read_b128 v[24:27], v16 offset:768
ds_read_b128 v[28:31], v16 offset:784
ds_read_b128 v[32:35], v16 offset:800
ds_read_b128 v[36:39], v16 offset:816
v_lshlrev_b32 v88, 16, v212
v_and_b32 v89, s54, v212
v_fma_f32 v88, v88, v92, v93
v_fma_f32 v89, v89, v92, v93
v_fmac_f32 v48, v88, v40
v_fmac_f32 v49, v89, v41
v_cvt_pk_bf16_f32 v212, v48, v49
v_lshlrev_b32 v90, 16, v213
v_and_b32 v91, s54, v213
v_fma_f32 v90, v90, v92, v93
v_fma_f32 v91, v91, v92, v93
v_mfma_f32_32x32x16_bf16 v[128:143], v[208:211], v[64:67], v[128:143]
v_fmac_f32 v50, v90, v42
v_fmac_f32 v51, v91, v43
v_cvt_pk_bf16_f32 v213, v50, v51
v_lshlrev_b32 v88, 16, v214
v_and_b32 v89, s54, v214
v_fma_f32 v88, v88, v92, v93
v_fma_f32 v89, v89, v92, v93
v_fmac_f32 v52, v88, v44
v_fmac_f32 v53, v89, v45
v_cvt_pk_bf16_f32 v214, v52, v53
v_lshlrev_b32 v90, 16, v215
v_and_b32 v91, s54, v215
v_fma_f32 v90, v90, v92, v93
v_fma_f32 v91, v91, v92, v93
v_fmac_f32 v54, v90, v46
v_fmac_f32 v55, v91, v47
v_cvt_pk_bf16_f32 v215, v54, v55
s_waitcnt lgkmcnt(0)
s_nop 0
v_mfma_f32_32x32x16_bf16 v[112:127], v[72:75], v[212:215], v[112:127]
ds_read_b64_tr_b16 v[60:61], v3 offset:19456
ds_read_b64_tr_b16 v[62:63], v3 offset:19712
ds_read_b64_tr_b16 v[64:65], v3 offset:20480
ds_read_b64_tr_b16 v[66:67], v3 offset:20736
ds_read_b128 v[40:43], v16 offset:896
ds_read_b128 v[44:47], v16 offset:912
ds_read_b128 v[48:51], v16 offset:928
ds_read_b128 v[52:55], v16 offset:944
v_lshlrev_b32 v88, 16, v216
v_and_b32 v89, s54, v216
v_fma_f32 v88, v88, v92, v93
v_fma_f32 v89, v89, v92, v93
v_fmac_f32 v32, v88, v24
v_fmac_f32 v33, v89, v25
v_cvt_pk_bf16_f32 v216, v32, v33
v_lshlrev_b32 v90, 16, v217
v_and_b32 v91, s54, v217
v_fma_f32 v90, v90, v92, v93
v_fma_f32 v91, v91, v92, v93
v_mfma_f32_32x32x16_bf16 v[128:143], v[212:215], v[76:79], v[128:143]
v_fmac_f32 v34, v90, v26
v_fmac_f32 v35, v91, v27
v_cvt_pk_bf16_f32 v217, v34, v35
v_lshlrev_b32 v88, 16, v218
v_and_b32 v89, s54, v218
v_fma_f32 v88, v88, v92, v93
v_fma_f32 v89, v89, v92, v93
v_fmac_f32 v36, v88, v28
v_fmac_f32 v37, v89, v29
v_cvt_pk_bf16_f32 v218, v36, v37
v_lshlrev_b32 v90, 16, v219
v_and_b32 v91, s54, v219
v_fma_f32 v90, v90, v92, v93
v_fma_f32 v91, v91, v92, v93
v_fmac_f32 v38, v90, v30
v_fmac_f32 v39, v91, v31
v_cvt_pk_bf16_f32 v219, v38, v39
s_waitcnt lgkmcnt(0)
s_nop 0
v_mfma_f32_32x32x16_bf16 v[112:127], v[60:63], v[216:219], v[112:127]
ds_read_b64_tr_b16 v[72:73], v3 offset:22528
ds_read_b64_tr_b16 v[74:75], v3 offset:22784
ds_read_b64_tr_b16 v[76:77], v3 offset:23552
ds_read_b64_tr_b16 v[78:79], v3 offset:23808
ds_read_b128 v[24:27], v16 offset:1024
ds_read_b128 v[28:31], v16 offset:1040
ds_read_b128 v[32:35], v16 offset:1056
ds_read_b128 v[36:39], v16 offset:1072
v_lshlrev_b32 v88, 16, v220
v_and_b32 v89, s54, v220
v_fma_f32 v88, v88, v92, v93
v_fma_f32 v89, v89, v92, v93
v_fmac_f32 v48, v88, v40
v_fmac_f32 v49, v89, v41
v_cvt_pk_bf16_f32 v220, v48, v49
v_lshlrev_b32 v90, 16, v221
v_and_b32 v91, s54, v221
v_fma_f32 v90, v90, v92, v93
v_fma_f32 v91, v91, v92, v93
v_mfma_f32_32x32x16_bf16 v[128:143], v[216:219], v[64:67], v[128:143]
v_fmac_f32 v50, v90, v42
v_fmac_f32 v51, v91, v43
v_cvt_pk_bf16_f32 v221, v50, v51
v_lshlrev_b32 v88, 16, v222
v_and_b32 v89, s54, v222
v_fma_f32 v88, v88, v92, v93
v_fma_f32 v89, v89, v92, v93
v_fmac_f32 v52, v88, v44
v_fmac_f32 v53, v89, v45
v_cvt_pk_bf16_f32 v222, v52, v53
v_lshlrev_b32 v90, 16, v223
v_and_b32 v91, s54, v223
v_fma_f32 v90, v90, v92, v93
v_fma_f32 v91, v91, v92, v93
v_fmac_f32 v54, v90, v46
v_fmac_f32 v55, v91, v47
v_cvt_pk_bf16_f32 v223, v54, v55
s_waitcnt lgkmcnt(0)
s_nop 0
v_mfma_f32_32x32x16_bf16 v[112:127], v[72:75], v[220:223], v[112:127]
ds_read_b64_tr_b16 v[60:61], v3 offset:25600
ds_read_b64_tr_b16 v[62:63], v3 offset:25856
ds_read_b64_tr_b16 v[64:65], v3 offset:26624
ds_read_b64_tr_b16 v[66:67], v3 offset:26880
ds_read_b128 v[40:43], v16 offset:1152
ds_read_b128 v[44:47], v16 offset:1168
ds_read_b128 v[48:51], v16 offset:1184
ds_read_b128 v[52:55], v16 offset:1200
v_lshlrev_b32 v88, 16, v224
v_and_b32 v89, s54, v224
v_fma_f32 v88, v88, v92, v93
v_fma_f32 v89, v89, v92, v93
v_fmac_f32 v32, v88, v24
v_fmac_f32 v33, v89, v25
v_cvt_pk_bf16_f32 v224, v32, v33
v_lshlrev_b32 v90, 16, v225
v_and_b32 v91, s54, v225
v_fma_f32 v90, v90, v92, v93
v_fma_f32 v91, v91, v92, v93
v_mfma_f32_32x32x16_bf16 v[128:143], v[220:223], v[76:79], v[128:143]
v_fmac_f32 v34, v90, v26
v_fmac_f32 v35, v91, v27
v_cvt_pk_bf16_f32 v225, v34, v35
v_lshlrev_b32 v88, 16, v226
v_and_b32 v89, s54, v226
v_fma_f32 v88, v88, v92, v93
v_fma_f32 v89, v89, v92, v93
v_fmac_f32 v36, v88, v28
v_fmac_f32 v37, v89, v29
v_cvt_pk_bf16_f32 v226, v36, v37
v_lshlrev_b32 v90, 16, v227
v_and_b32 v91, s54, v227
v_fma_f32 v90, v90, v92, v93
v_fma_f32 v91, v91, v92, v93
v_fmac_f32 v38, v90, v30
v_fmac_f32 v39, v91, v31
v_cvt_pk_bf16_f32 v227, v38, v39
s_waitcnt lgkmcnt(0)
s_nop 0
v_mfma_f32_32x32x16_bf16 v[112:127], v[60:63], v[224:227], v[112:127]
ds_read_b64_tr_b16 v[72:73], v3 offset:28672
ds_read_b64_tr_b16 v[74:75], v3 offset:28928
ds_read_b64_tr_b16 v[76:77], v3 offset:29696
ds_read_b64_tr_b16 v[78:79], v3 offset:29952
ds_read_b128 v[24:27], v16 offset:1280
ds_read_b128 v[28:31], v16 offset:1296
ds_read_b128 v[32:35], v16 offset:1312
ds_read_b128 v[36:39], v16 offset:1328
v_lshlrev_b32 v88, 16, v228
v_and_b32 v89, s54, v228
v_fma_f32 v88, v88, v92, v93
v_fma_f32 v89, v89, v92, v93
v_fmac_f32 v48, v88, v40
v_fmac_f32 v49, v89, v41
v_cvt_pk_bf16_f32 v228, v48, v49
v_lshlrev_b32 v90, 16, v229
v_and_b32 v91, s54, v229
v_fma_f32 v90, v90, v92, v93
v_fma_f32 v91, v91, v92, v93
v_mfma_f32_32x32x16_bf16 v[128:143], v[224:227], v[64:67], v[128:143]
v_fmac_f32 v50, v90, v42
v_fmac_f32 v51, v91, v43
v_cvt_pk_bf16_f32 v229, v50, v51
v_lshlrev_b32 v88, 16, v230
v_and_b32 v89, s54, v230
v_fma_f32 v88, v88, v92, v93
v_fma_f32 v89, v89, v92, v93
v_fmac_f32 v52, v88, v44
v_fmac_f32 v53, v89, v45
v_cvt_pk_bf16_f32 v230, v52, v53
v_lshlrev_b32 v90, 16, v231
v_and_b32 v91, s54, v231
v_fma_f32 v90, v90, v92, v93
v_fma_f32 v91, v91, v92, v93
v_fmac_f32 v54, v90, v46
v_fmac_f32 v55, v91, v47
v_cvt_pk_bf16_f32 v231, v54, v55
s_waitcnt lgkmcnt(0)
s_nop 0
v_mfma_f32_32x32x16_bf16 v[112:127], v[72:75], v[228:231], v[112:127]
ds_read_b64_tr_b16 v[60:61], v3 offset:31744
ds_read_b64_tr_b16 v[62:63], v3 offset:32000
ds_read_b64_tr_b16 v[64:65], v3 offset:32768
ds_read_b64_tr_b16 v[66:67], v3 offset:33024
ds_read_b128 v[40:43], v16 offset:1408
ds_read_b128 v[44:47], v16 offset:1424
ds_read_b128 v[48:51], v16 offset:1440
ds_read_b128 v[52:55], v16 offset:1456
v_lshlrev_b32 v88, 16, v232
v_and_b32 v89, s54, v232
v_fma_f32 v88, v88, v92, v93
v_fma_f32 v89, v89, v92, v93
v_fmac_f32 v32, v88, v24
v_fmac_f32 v33, v89, v25
v_cvt_pk_bf16_f32 v232, v32, v33
v_lshlrev_b32 v90, 16, v233
v_and_b32 v91, s54, v233
v_fma_f32 v90, v90, v92, v93
v_fma_f32 v91, v91, v92, v93
v_mfma_f32_32x32x16_bf16 v[128:143], v[228:231], v[76:79], v[128:143]
v_fmac_f32 v34, v90, v26
v_fmac_f32 v35, v91, v27
v_cvt_pk_bf16_f32 v233, v34, v35
v_lshlrev_b32 v88, 16, v234
v_and_b32 v89, s54, v234
v_fma_f32 v88, v88, v92, v93
v_fma_f32 v89, v89, v92, v93
v_fmac_f32 v36, v88, v28
v_fmac_f32 v37, v89, v29
v_cvt_pk_bf16_f32 v234, v36, v37
v_lshlrev_b32 v90, 16, v235
v_and_b32 v91, s54, v235
v_fma_f32 v90, v90, v92, v93
v_fma_f32 v91, v91, v92, v93
v_fmac_f32 v38, v90, v30
v_fmac_f32 v39, v91, v31
v_cvt_pk_bf16_f32 v235, v38, v39
s_waitcnt lgkmcnt(0)
s_nop 0
v_mfma_f32_32x32x16_bf16 v[112:127], v[60:63], v[232:235], v[112:127]
ds_read_b64_tr_b16 v[72:73], v3 offset:34816
ds_read_b64_tr_b16 v[74:75], v3 offset:35072
ds_read_b64_tr_b16 v[76:77], v3 offset:35840
ds_read_b64_tr_b16 v[78:79], v3 offset:36096
ds_read_b128 v[24:27], v16 offset:1536
ds_read_b128 v[28:31], v16 offset:1552
ds_read_b128 v[32:35], v16 offset:1568
ds_read_b128 v[36:39], v16 offset:1584
v_lshlrev_b32 v88, 16, v236
v_and_b32 v89, s54, v236
v_fma_f32 v88, v88, v92, v93
v_fma_f32 v89, v89, v92, v93
v_fmac_f32 v48, v88, v40
v_fmac_f32 v49, v89, v41
v_cvt_pk_bf16_f32 v236, v48, v49
v_lshlrev_b32 v90, 16, v237
v_and_b32 v91, s54, v237
v_fma_f32 v90, v90, v92, v93
v_fma_f32 v91, v91, v92, v93
v_mfma_f32_32x32x16_bf16 v[128:143], v[232:235], v[64:67], v[128:143]
v_fmac_f32 v50, v90, v42
v_fmac_f32 v51, v91, v43
v_cvt_pk_bf16_f32 v237, v50, v51
v_lshlrev_b32 v88, 16, v238
v_and_b32 v89, s54, v238
v_fma_f32 v88, v88, v92, v93
v_fma_f32 v89, v89, v92, v93
v_fmac_f32 v52, v88, v44
v_fmac_f32 v53, v89, v45
v_cvt_pk_bf16_f32 v238, v52, v53
v_lshlrev_b32 v90, 16, v239
v_and_b32 v91, s54, v239
v_fma_f32 v90, v90, v92, v93
v_fma_f32 v91, v91, v92, v93
v_fmac_f32 v54, v90, v46
v_fmac_f32 v55, v91, v47
v_cvt_pk_bf16_f32 v239, v54, v55
s_waitcnt lgkmcnt(0)
s_nop 0
v_mfma_f32_32x32x16_bf16 v[112:127], v[72:75], v[236:239], v[112:127]
ds_read_b64_tr_b16 v[60:61], v3 offset:37888
ds_read_b64_tr_b16 v[62:63], v3 offset:38144
ds_read_b64_tr_b16 v[64:65], v3 offset:38912
ds_read_b64_tr_b16 v[66:67], v3 offset:39168
ds_read_b128 v[40:43], v16 offset:1664
ds_read_b128 v[44:47], v16 offset:1680
ds_read_b128 v[48:51], v16 offset:1696
ds_read_b128 v[52:55], v16 offset:1712
v_lshlrev_b32 v88, 16, v240
v_and_b32 v89, s54, v240
v_fma_f32 v88, v88, v92, v93
v_fma_f32 v89, v89, v92, v93
v_fmac_f32 v32, v88, v24
v_fmac_f32 v33, v89, v25
v_cvt_pk_bf16_f32 v240, v32, v33
v_lshlrev_b32 v90, 16, v241
v_and_b32 v91, s54, v241
v_fma_f32 v90, v90, v92, v93
v_fma_f32 v91, v91, v92, v93
v_mfma_f32_32x32x16_bf16 v[128:143], v[236:239], v[76:79], v[128:143]
v_fmac_f32 v34, v90, v26
v_fmac_f32 v35, v91, v27
v_cvt_pk_bf16_f32 v241, v34, v35
v_lshlrev_b32 v88, 16, v242
v_and_b32 v89, s54, v242
v_fma_f32 v88, v88, v92, v93
v_fma_f32 v89, v89, v92, v93
v_fmac_f32 v36, v88, v28
v_fmac_f32 v37, v89, v29
v_cvt_pk_bf16_f32 v242, v36, v37
v_lshlrev_b32 v90, 16, v243
v_and_b32 v91, s54, v243
v_fma_f32 v90, v90, v92, v93
v_fma_f32 v91, v91, v92, v93
v_fmac_f32 v38, v90, v30
v_fmac_f32 v39, v91, v31
v_cvt_pk_bf16_f32 v243, v38, v39
s_waitcnt lgkmcnt(0)
s_nop 0
v_mfma_f32_32x32x16_bf16 v[112:127], v[60:63], v[240:243], v[112:127]
ds_read_b64_tr_b16 v[72:73], v3 offset:40960
ds_read_b64_tr_b16 v[74:75], v3 offset:41216
ds_read_b64_tr_b16 v[76:77], v3 offset:41984
ds_read_b64_tr_b16 v[78:79], v3 offset:42240
ds_read_b128 v[24:27], v16 offset:1792
ds_read_b128 v[28:31], v16 offset:1808
ds_read_b128 v[32:35], v16 offset:1824
ds_read_b128 v[36:39], v16 offset:1840
v_lshlrev_b32 v88, 16, v244
v_and_b32 v89, s54, v244
v_fma_f32 v88, v88, v92, v93
v_fma_f32 v89, v89, v92, v93
v_fmac_f32 v48, v88, v40
v_fmac_f32 v49, v89, v41
v_cvt_pk_bf16_f32 v244, v48, v49
v_lshlrev_b32 v90, 16, v245
v_and_b32 v91, s54, v245
v_fma_f32 v90, v90, v92, v93
v_fma_f32 v91, v91, v92, v93
v_mfma_f32_32x32x16_bf16 v[128:143], v[240:243], v[64:67], v[128:143]
v_fmac_f32 v50, v90, v42
v_fmac_f32 v51, v91, v43
v_cvt_pk_bf16_f32 v245, v50, v51
v_lshlrev_b32 v88, 16, v246
v_and_b32 v89, s54, v246
v_fma_f32 v88, v88, v92, v93
v_fma_f32 v89, v89, v92, v93
v_fmac_f32 v52, v88, v44
v_fmac_f32 v53, v89, v45
v_cvt_pk_bf16_f32 v246, v52, v53
v_lshlrev_b32 v90, 16, v247
v_and_b32 v91, s54, v247
v_fma_f32 v90, v90, v92, v93
v_fma_f32 v91, v91, v92, v93
v_fmac_f32 v54, v90, v46
v_fmac_f32 v55, v91, v47
v_cvt_pk_bf16_f32 v247, v54, v55
s_waitcnt lgkmcnt(0)
s_nop 0
v_mfma_f32_32x32x16_bf16 v[112:127], v[72:75], v[244:247], v[112:127]
ds_read_b64_tr_b16 v[60:61], v3 offset:44032
ds_read_b64_tr_b16 v[62:63], v3 offset:44288
ds_read_b64_tr_b16 v[64:65], v3 offset:45056
ds_read_b64_tr_b16 v[66:67], v3 offset:45312
ds_read_b128 v[40:43], v16 offset:1920
ds_read_b128 v[44:47], v16 offset:1936
ds_read_b128 v[48:51], v16 offset:1952
ds_read_b128 v[52:55], v16 offset:1968
v_lshlrev_b32 v88, 16, v248
v_and_b32 v89, s54, v248
v_fma_f32 v88, v88, v92, v93
v_fma_f32 v89, v89, v92, v93
v_fmac_f32 v32, v88, v24
v_fmac_f32 v33, v89, v25
v_cvt_pk_bf16_f32 v248, v32, v33
v_lshlrev_b32 v90, 16, v249
v_and_b32 v91, s54, v249
v_fma_f32 v90, v90, v92, v93
v_fma_f32 v91, v91, v92, v93
v_mfma_f32_32x32x16_bf16 v[128:143], v[244:247], v[76:79], v[128:143]
v_fmac_f32 v34, v90, v26
v_fmac_f32 v35, v91, v27
v_cvt_pk_bf16_f32 v249, v34, v35
v_lshlrev_b32 v88, 16, v250
v_and_b32 v89, s54, v250
v_fma_f32 v88, v88, v92, v93
v_fma_f32 v89, v89, v92, v93
v_fmac_f32 v36, v88, v28
v_fmac_f32 v37, v89, v29
v_cvt_pk_bf16_f32 v250, v36, v37
v_lshlrev_b32 v90, 16, v251
v_and_b32 v91, s54, v251
v_fma_f32 v90, v90, v92, v93
v_fma_f32 v91, v91, v92, v93
v_fmac_f32 v38, v90, v30
v_fmac_f32 v39, v91, v31
v_cvt_pk_bf16_f32 v251, v38, v39
s_waitcnt lgkmcnt(0)
s_nop 0
v_mfma_f32_32x32x16_bf16 v[112:127], v[60:63], v[248:251], v[112:127]
ds_read_b64_tr_b16 v[72:73], v3 offset:47104
ds_read_b64_tr_b16 v[74:75], v3 offset:47360
ds_read_b64_tr_b16 v[76:77], v3 offset:48128
ds_read_b64_tr_b16 v[78:79], v3 offset:48384
v_lshlrev_b32 v88, 16, v252
v_and_b32 v89, s54, v252
v_fma_f32 v88, v88, v92, v93
v_fma_f32 v89, v89, v92, v93
v_fmac_f32 v48, v88, v40
v_fmac_f32 v49, v89, v41
v_cvt_pk_bf16_f32 v252, v48, v49
v_lshlrev_b32 v90, 16, v253
v_and_b32 v91, s54, v253
v_fma_f32 v90, v90, v92, v93
v_fma_f32 v91, v91, v92, v93
v_fmac_f32 v50, v90, v42
v_fmac_f32 v51, v91, v43
v_mfma_f32_32x32x16_bf16 v[128:143], v[248:251], v[64:67], v[128:143]
v_cvt_pk_bf16_f32 v253, v50, v51
v_lshlrev_b32 v88, 16, v254
v_and_b32 v89, s54, v254
v_fma_f32 v88, v88, v92, v93
v_fma_f32 v89, v89, v92, v93
v_fmac_f32 v52, v88, v44
v_fmac_f32 v53, v89, v45
v_cvt_pk_bf16_f32 v254, v52, v53
v_lshlrev_b32 v90, 16, v255
v_and_b32 v91, s54, v255
v_fma_f32 v90, v90, v92, v93
v_fma_f32 v91, v91, v92, v93
v_fmac_f32 v54, v90, v46
v_fmac_f32 v55, v91, v47
v_cvt_pk_bf16_f32 v255, v54, v55
s_waitcnt lgkmcnt(0)
s_nop 0
v_mfma_f32_32x32x16_bf16 v[112:127], v[72:75], v[252:255], v[112:127]
v_mfma_f32_32x32x16_bf16 v[128:143], v[252:255], v[76:79], v[128:143]
s_mul_i32 s49, s46, 6144
s_add_u32 s49, s49, 102400
v_add_u32 v16, s49, v1
s_xor_b32 s50, s46, 4
s_mul_i32 s49, s50, 6144
s_add_u32 s49, s49, 102400
v_add_u32 v17, s49, v1
s_lshl_b32 s49, s62, 11
s_lshl_b32 s51, s56, 10
s_add_u32 s49, s49, s51
v_add_u32 v18, s49, v1
s_mul_i32 s50, s62, 2080
s_add_u32 s50, s50, 24576
s_lshl_b32 s49, s56, 8
s_add_u32 s49, s49, s50
s_add_u32 s51, s50, 1024
v_add_u32 v20, s49, v1
v_mov_b32 v7, s51
v_and_b32 v6, 256, v1
v_cmp_eq_u32 vcc, 0, v6
s_nop 1
v_cndmask_b32 v20, v7, v20, vcc
s_mul_i32 s49, s56, 1040
s_add_u32 s49, s49, s50
v_add_u32 v19, s49, v1
ds_read_b64_tr_b16 v[160:161], v3 offset:0
ds_read_b64_tr_b16 v[162:163], v3 offset:256
ds_read_b64_tr_b16 v[164:165], v3 offset:3072
ds_read_b64_tr_b16 v[166:167], v3 offset:3328
ds_read_b64_tr_b16 v[168:169], v3 offset:6144
ds_read_b64_tr_b16 v[170:171], v3 offset:6400
ds_read_b64_tr_b16 v[172:173], v3 offset:9216
ds_read_b64_tr_b16 v[174:175], v3 offset:9472
ds_read_b64_tr_b16 v[176:177], v3 offset:12288
ds_read_b64_tr_b16 v[178:179], v3 offset:12544
ds_read_b64_tr_b16 v[180:181], v3 offset:15360
ds_read_b64_tr_b16 v[182:183], v3 offset:15616
ds_read_b64_tr_b16 v[184:185], v3 offset:18432
ds_read_b64_tr_b16 v[186:187], v3 offset:18688
ds_read_b64_tr_b16 v[188:189], v3 offset:21504
ds_read_b64_tr_b16 v[190:191], v3 offset:21760
ds_read_b64_tr_b16 v[56:57], v3 offset:24576
ds_read_b64_tr_b16 v[58:59], v3 offset:24832
ds_read_b64_tr_b16 v[60:61], v3 offset:27648
ds_read_b64_tr_b16 v[62:63], v3 offset:27904
ds_read_b64_tr_b16 v[64:65], v3 offset:30720
ds_read_b64_tr_b16 v[66:67], v3 offset:30976
ds_read_b64_tr_b16 v[68:69], v3 offset:33792
ds_read_b64_tr_b16 v[70:71], v3 offset:34048
ds_read_b64_tr_b16 v[72:73], v3 offset:36864
ds_read_b64_tr_b16 v[74:75], v3 offset:37120
ds_read_b64_tr_b16 v[76:77], v3 offset:39936
ds_read_b64_tr_b16 v[78:79], v3 offset:40192
ds_read_b64_tr_b16 v[80:81], v3 offset:43008
ds_read_b64_tr_b16 v[82:83], v3 offset:43264
ds_read_b64_tr_b16 v[84:85], v3 offset:46080
ds_read_b64_tr_b16 v[86:87], v3 offset:46336
s_waitcnt lgkmcnt(0)
s_barrier
s_cmp_lg_u32 s56, 0
s_cbranch_scc1 Lb5
ds_write_b128 v16, v[120:123] offset:2048
ds_write_b128 v16, v[124:127] offset:3072
ds_write_b128 v16, v[136:139] offset:4096
ds_write_b128 v16, v[140:143] offset:5120
s_waitcnt lgkmcnt(0)
s_branch Lb6
Lb5:
s_nop 7
s_nop 3
ds_write_b128 v16, v[112:115] offset:2048
ds_write_b128 v16, v[116:119] offset:3072
ds_write_b128 v16, v[128:131] offset:4096
ds_write_b128 v16, v[132:135] offset:5120
s_waitcnt lgkmcnt(0)
Lb6:
s_barrier
ds_read_b128 v[32:35], v17 offset:2048
ds_read_b128 v[36:39], v17 offset:3072
ds_read_b128 v[40:43], v17 offset:4096
ds_read_b128 v[44:47], v17 offset:5120
s_lshl_b32 s58, s48, 16
s_lshl_b32 s51, s45, 12
s_add_u32 s58, s58, s51
s_lshl_b32 s51, s56, 10
s_add_u32 s58, s58, s51
s_add_u32 s58, s58, 1048576
s_waitcnt lgkmcnt(0)
s_cmp_lg_u32 s56, 0
s_cbranch_scc1 Lb7
v_add_f32 v32, v32, v112
v_add_f32 v33, v33, v113
v_add_f32 v34, v34, v114
v_add_f32 v35, v35, v115
v_add_f32 v36, v36, v116
v_add_f32 v37, v37, v117
v_add_f32 v38, v38, v118
v_add_f32 v39, v39, v119
v_add_f32 v40, v40, v128
v_add_f32 v41, v41, v129
v_add_f32 v42, v42, v130
v_add_f32 v43, v43, v131
v_add_f32 v44, v44, v132
v_add_f32 v45, v45, v133
v_add_f32 v46, v46, v134
v_add_f32 v47, v47, v135
s_waitcnt lgkmcnt(0)
s_branch Lb8
Lb7:
s_nop 7
s_nop 3
v_add_f32 v32, v32, v120
v_add_f32 v33, v33, v121
v_add_f32 v34, v34, v122
v_add_f32 v35, v35, v123
v_add_f32 v36, v36, v124
v_add_f32 v37, v37, v125
v_add_f32 v38, v38, v126
v_add_f32 v39, v39, v127
v_add_f32 v40, v40, v136
v_add_f32 v41, v41, v137
v_add_f32 v42, v42, v138
v_add_f32 v43, v43, v139
v_add_f32 v44, v44, v140
v_add_f32 v45, v45, v141
v_add_f32 v46, v46, v142
v_add_f32 v47, v47, v143
s_waitcnt lgkmcnt(0)
Lb8:
v_cvt_pk_bf16_f32 v48, v32, v33
v_cvt_pk_bf16_f32 v52, v40, v41
v_cvt_pk_bf16_f32 v49, v34, v35
v_cvt_pk_bf16_f32 v53, v42, v43
v_cvt_pk_bf16_f32 v50, v36, v37
v_cvt_pk_bf16_f32 v54, v44, v45
v_cvt_pk_bf16_f32 v51, v38, v39
v_cvt_pk_bf16_f32 v55, v46, v47
buffer_store_dwordx4 v[48:51], v1, s[32:35], s58 offen sc1
buffer_store_dwordx4 v[52:55], v1, s[32:35], s58 offen offset:2048 sc1
ds_write_b128 v18, v[48:51] offset:16384
ds_write_b128 v19, v[52:55] offset:16640
s_lshl_b32 s49, s44, 3
s_sub_i32 s59, 16, s49
s_max_i32 s59, s59, 0
v_lshrrev_b32 v6, 4, v1
v_min_u32 v6, 23, v6
v_mov_b32 v7, s53
v_cmp_le_u32 vcc, s59, v6
v_mul_u32_u24 v6, 1040, v6
s_nop 0
v_cndmask_b32 v40, 0, v7, vcc
v_mov_b32 v41, v40
v_mov_b32 v42, v40
v_mov_b32 v43, v40
ds_write_b128 v6, v[40:43] offset:25600
s_waitcnt vmcnt(2)
v_lshlrev_b32 v6, 16, v144
v_and_b32 v7, s54, v144
v_mul_f32 v88, v6, v148
v_mul_f32 v89, v7, v148
v_lshlrev_b32 v6, 16, v145
v_and_b32 v7, s54, v145
v_mul_f32 v90, v6, v148
v_mul_f32 v91, v7, v148
v_lshlrev_b32 v6, 16, v146
v_and_b32 v7, s54, v146
v_mul_f32 v92, v6, v148
v_mul_f32 v93, v7, v148
v_lshlrev_b32 v6, 16, v147
v_and_b32 v7, s54, v147
v_mul_f32 v94, v6, v148
v_mul_f32 v95, v7, v148
v_add_f32_dpp v88, v88, v88 row_shr:1 bound_ctrl:0
v_add_f32_dpp v89, v89, v89 row_shr:1 bound_ctrl:0
v_add_f32_dpp v90, v90, v90 row_shr:1 bound_ctrl:0
v_add_f32_dpp v91, v91, v91 row_shr:1 bound_ctrl:0
v_add_f32_dpp v92, v92, v92 row_shr:1 bound_ctrl:0
v_add_f32_dpp v93, v93, v93 row_shr:1 bound_ctrl:0
v_add_f32_dpp v94, v94, v94 row_shr:1 bound_ctrl:0
v_add_f32_dpp v95, v95, v95 row_shr:1 bound_ctrl:0
v_add_f32_dpp v88, v88, v88 row_shr:2 bound_ctrl:0
v_add_f32_dpp v89, v89, v89 row_shr:2 bound_ctrl:0
v_add_f32_dpp v90, v90, v90 row_shr:2 bound_ctrl:0
v_add_f32_dpp v91, v91, v91 row_shr:2 bound_ctrl:0
v_add_f32_dpp v92, v92, v92 row_shr:2 bound_ctrl:0
v_add_f32_dpp v93, v93, v93 row_shr:2 bound_ctrl:0
v_add_f32_dpp v94, v94, v94 row_shr:2 bound_ctrl:0
v_add_f32_dpp v95, v95, v95 row_shr:2 bound_ctrl:0
v_add_f32_dpp v88, v88, v88 row_shr:4 bound_ctrl:0
v_add_f32_dpp v89, v89, v89 row_shr:4 bound_ctrl:0
v_add_f32_dpp v90, v90, v90 row_shr:4 bound_ctrl:0
v_add_f32_dpp v91, v91, v91 row_shr:4 bound_ctrl:0
v_add_f32_dpp v92, v92, v92 row_shr:4 bound_ctrl:0
v_add_f32_dpp v93, v93, v93 row_shr:4 bound_ctrl:0
v_add_f32_dpp v94, v94, v94 row_shr:4 bound_ctrl:0
v_add_f32_dpp v95, v95, v95 row_shr:4 bound_ctrl:0
v_add_f32_dpp v88, v88, v88 row_shr:8 bound_ctrl:0
v_add_f32_dpp v89, v89, v89 row_shr:8 bound_ctrl:0
v_add_f32_dpp v90, v90, v90 row_shr:8 bound_ctrl:0
v_add_f32_dpp v91, v91, v91 row_shr:8 bound_ctrl:0
v_add_f32_dpp v92, v92, v92 row_shr:8 bound_ctrl:0
v_add_f32_dpp v93, v93, v93 row_shr:8 bound_ctrl:0
v_add_f32_dpp v94, v94, v94 row_shr:8 bound_ctrl:0
v_add_f32_dpp v95, v95, v95 row_shr:8 bound_ctrl:0
v_add_f32_dpp v88, v88, v88 row_bcast:15 row_mask:0xa
v_add_f32_dpp v89, v89, v89 row_bcast:15 row_mask:0xa
v_add_f32_dpp v90, v90, v90 row_bcast:15 row_mask:0xa
v_add_f32_dpp v91, v91, v91 row_bcast:15 row_mask:0xa
v_add_f32_dpp v92, v92, v92 row_bcast:15 row_mask:0xa
v_add_f32_dpp v93, v93, v93 row_bcast:15 row_mask:0xa
v_add_f32_dpp v94, v94, v94 row_bcast:15 row_mask:0xa
v_add_f32_dpp v95, v95, v95 row_bcast:15 row_mask:0xa
v_add_f32_dpp v88, v88, v88 row_bcast:31 row_mask:0xc
v_add_f32_dpp v89, v89, v89 row_bcast:31 row_mask:0xc
v_add_f32_dpp v90, v90, v90 row_bcast:31 row_mask:0xc
v_add_f32_dpp v91, v91, v91 row_bcast:31 row_mask:0xc
v_add_f32_dpp v92, v92, v92 row_bcast:31 row_mask:0xc
v_add_f32_dpp v93, v93, v93 row_bcast:31 row_mask:0xc
v_add_f32_dpp v94, v94, v94 row_bcast:31 row_mask:0xc
v_add_f32_dpp v95, v95, v95 row_bcast:31 row_mask:0xc
s_mul_i32 s49, s46, 32
s_add_u32 s49, s49, 163456
v_mov_b32 v6, s49
s_mov_b32 exec_lo, 0
s_mov_b32 exec_hi, 0x80000000
ds_write_b128 v6, v[88:91] offset:0
ds_write_b128 v6, v[92:95] offset:16
s_mov_b64 exec, -1
v_mfma_f32_32x32x16_bf16 v[96:111], v[160:163], v[192:195], 0
v_mfma_f32_32x32x16_bf16 v[96:111], v[164:167], v[196:199], v[96:111]
v_mfma_f32_32x32x16_bf16 v[96:111], v[168:171], v[200:203], v[96:111]
v_mfma_f32_32x32x16_bf16 v[96:111], v[172:175], v[204:207], v[96:111]
v_mfma_f32_32x32x16_bf16 v[96:111], v[176:179], v[208:211], v[96:111]
v_mfma_f32_32x32x16_bf16 v[96:111], v[180:183], v[212:215], v[96:111]
v_mfma_f32_32x32x16_bf16 v[96:111], v[184:187], v[216:219], v[96:111]
v_mfma_f32_32x32x16_bf16 v[96:111], v[188:191], v[220:223], v[96:111]
v_mfma_f32_32x32x16_bf16 v[96:111], v[56:59], v[224:227], v[96:111]
v_mfma_f32_32x32x16_bf16 v[96:111], v[60:63], v[228:231], v[96:111]
v_mfma_f32_32x32x16_bf16 v[96:111], v[64:67], v[232:235], v[96:111]
v_mfma_f32_32x32x16_bf16 v[96:111], v[68:71], v[236:239], v[96:111]
v_mfma_f32_32x32x16_bf16 v[96:111], v[72:75], v[240:243], v[96:111]
v_mfma_f32_32x32x16_bf16 v[96:111], v[76:79], v[244:247], v[96:111]
v_mfma_f32_32x32x16_bf16 v[96:111], v[80:83], v[248:251], v[96:111]
v_mfma_f32_32x32x16_bf16 v[96:111], v[84:87], v[252:255], v[96:111]
s_waitcnt vmcnt(0)
s_waitcnt lgkmcnt(0)
s_barrier
s_cmp_lg_u32 s46, 7
s_cbranch_scc1 Ls9
s_lshl_b32 s58, s45, 5
s_lshl_b32 s51, s44, 0
s_add_u32 s58, s58, s51
s_lshl_b32 s50, s58, 2
s_add_u32 s50, s50, 32768
v_mov_b32 v6, s47
v_mov_b32 v7, 0
s_mov_b64 exec, 1
buffer_store_dword v6, v7, s[32:35], s50 offen sc1
s_mov_b64 exec, -1
Ls9:
s_cmp_lg_u32 s56, 0
s_cbranch_scc1 Lb10
ds_write_b128 v16, v[104:107] offset:13312
ds_write_b128 v16, v[108:111] offset:14336
s_waitcnt lgkmcnt(0)
s_branch Lb11
Lb10:
s_nop 7
s_nop 3
ds_write_b128 v16, v[96:99] offset:13312
ds_write_b128 v16, v[100:103] offset:14336
s_waitcnt lgkmcnt(0)
Lb11:
s_barrier
ds_read_b128 v[24:27], v17 offset:13312
ds_read_b128 v[28:31], v17 offset:14336
s_waitcnt lgkmcnt(0)
s_cmp_lg_u32 s56, 0
s_cbranch_scc1 Lb12
v_add_f32 v24, v24, v96
v_add_f32 v25, v25, v97
v_add_f32 v26, v26, v98
v_add_f32 v27, v27, v99
v_add_f32 v28, v28, v100
v_add_f32 v29, v29, v101
v_add_f32 v30, v30, v102
v_add_f32 v31, v31, v103
s_waitcnt lgkmcnt(0)
s_branch Lb13
Lb12:
s_nop 7
s_nop 3
v_add_f32 v24, v24, v104
v_add_f32 v25, v25, v105
v_add_f32 v26, v26, v106
v_add_f32 v27, v27, v107
v_add_f32 v28, v28, v108
v_add_f32 v29, v29, v109
v_add_f32 v30, v30, v110
v_add_f32 v31, v31, v111
s_waitcnt lgkmcnt(0)
Lb13:
v_mul_f32 v24, 0x3eb8aa3b, v24
v_mul_f32 v25, 0x3eb8aa3b, v25
v_cvt_pk_bf16_f32 v12, v24, v25
v_mul_f32 v26, 0x3eb8aa3b, v26
v_mul_f32 v27, 0x3eb8aa3b, v27
v_cvt_pk_bf16_f32 v13, v26, v27
v_mul_f32 v28, 0x3eb8aa3b, v28
v_mul_f32 v29, 0x3eb8aa3b, v29
v_cvt_pk_bf16_f32 v14, v28, v29
v_mul_f32 v30, 0x3eb8aa3b, v30
v_mul_f32 v31, 0x3eb8aa3b, v31
v_cvt_pk_bf16_f32 v15, v30, v31
v_lshrrev_b32 v6, 6, v1
v_and_b32 v7, 3, v6
v_bfe_u32 v5, v6, 2, 1
v_lshl_add_u32 v7, v5, 3, v7
v_lshrrev_b32 v6, 3, v6
v_lshl_add_u32 v6, v6, 2, v7
v_mul_u32_u24 v6, 1024, v6
v_and_b32 v7, 48, v1
v_add_u32 v5, v6, v7
s_lshl_b32 s41, s46, 16
s_lshl_b32 s51, s57, 7
s_add_u32 s41, s41, s51
s_lshl_b32 s42, s46, 13
s_add_u32 s42, s42, 50176
s_add_u32 m0, s42, 0
s_add_u32 s49, s41, 0
buffer_load_dwordx4 v5, s[12:15], s49 offen lds
s_add_u32 m0, s42, 1024
s_add_u32 s49, s41, 64
buffer_load_dwordx4 v5, s[12:15], s49 offen lds
s_add_u32 m0, s42, 2048
s_add_u32 s49, s41, 16384
buffer_load_dwordx4 v5, s[12:15], s49 offen lds
s_add_u32 m0, s42, 3072
s_add_u32 s49, s41, 16448
buffer_load_dwordx4 v5, s[12:15], s49 offen lds
s_add_u32 m0, s42, 4096
s_add_u32 s49, s41, 32768
buffer_load_dwordx4 v5, s[12:15], s49 offen lds
s_add_u32 m0, s42, 5120
s_add_u32 s49, s41, 32832
buffer_load_dwordx4 v5, s[12:15], s49 offen lds
s_add_u32 m0, s42, 6144
s_add_u32 s49, s41, 49152
buffer_load_dwordx4 v5, s[12:15], s49 offen lds
s_add_u32 m0, s42, 7168
s_add_u32 s49, s41, 49216
buffer_load_dwordx4 v5, s[12:15], s49 offen lds
s_mov_b32 s64, 4294967295
s_mov_b32 s65, 4294967280
s_mov_b32 s66, 4294967294
s_mov_b32 s67, 4294967264
s_mov_b32 s68, 4294967292
s_mov_b32 s69, 4294967232
s_mov_b32 s70, 4294967288
s_mov_b32 s71, 4294967168
s_mov_b32 s72, 4294967040
s_mov_b32 s73, 4294963200
s_mov_b32 s74, 4294966784
s_mov_b32 s75, 4294959104
s_mov_b32 s76, 4294966272
s_mov_b32 s77, 4294950912
s_mov_b32 s78, 4294965248
s_mov_b32 s79, 4294934528
s_mov_b32 s80, 4294901760
s_mov_b32 s81, 4293918720
s_mov_b32 s82, 4294836224
s_mov_b32 s83, 4292870144
s_mov_b32 s84, 4294705152
s_mov_b32 s85, 4290772992
s_mov_b32 s86, 4294443008
s_mov_b32 s87, 4286578688
s_mov_b32 s88, 4278190080
s_mov_b32 s89, 4026531840
s_mov_b32 s90, 4261412864
s_mov_b32 s91, 3758096384
s_mov_b32 s92, 4227858432
s_mov_b32 s93, 3221225472
s_mov_b32 s94, 4160749568
s_mov_b32 s95, 2147483648
v_mov_b32 v6, 0xffff
v_mov_b32 v7, s54
v_cndmask_b32 v40, 0, v6, s[64:65]
v_cndmask_b32 v41, 0, v7, s[66:67]
v_or_b32 v208, v40, v41
v_cndmask_b32 v40, 0, v6, s[68:69]
v_cndmask_b32 v41, 0, v7, s[70:71]
v_or_b32 v209, v40, v41
v_cndmask_b32 v40, 0, v6, s[72:73]
v_cndmask_b32 v41, 0, v7, s[74:75]
v_or_b32 v210, v40, v41
v_cndmask_b32 v40, 0, v6, s[76:77]
v_cndmask_b32 v41, 0, v7, s[78:79]
v_or_b32 v211, v40, v41
v_cndmask_b32 v40, 0, v6, s[80:81]
v_cndmask_b32 v41, 0, v7, s[82:83]
v_or_b32 v212, v40, v41
v_cndmask_b32 v40, 0, v6, s[84:85]
v_cndmask_b32 v41, 0, v7, s[86:87]
v_or_b32 v213, v40, v41
v_cndmask_b32 v40, 0, v6, s[88:89]
v_cndmask_b32 v41, 0, v7, s[90:91]
v_or_b32 v214, v40, v41
v_cndmask_b32 v40, 0, v6, s[92:93]
v_cndmask_b32 v41, 0, v7, s[94:95]
v_or_b32 v215, v40, v41
s_cmp_lg_u32 s46, 0
s_cbranch_scc1 Lg14
s_cmp_eq_u32 s44, 0
s_cbranch_scc1 Lnohalo0
s_sub_i32 s49, s44, 2
v_bfe_u32 v7, v1, 4, 1
v_add_u32 v7, s49, v7
v_max_i32 v7, 0, v7
v_lshlrev_b32 v7, 2, v7
s_lshl_b32 s50, s45, 5
s_lshl_b32 s50, s50, 2
s_add_u32 s50, s50, 32768
s_mov_b32 s52, 400000
Lp15:
buffer_load_dword v22, v7, s[32:35], s50 offen sc1
s_waitcnt vmcnt(0)
v_cmp_ne_u32 vcc, s47, v22
s_nop 0
s_cbranch_vccz Ld16
s_sub_u32 s52, s52, 1
s_cmp_lg_u32 s52, 0
s_cbranch_scc1 Lp15
Ld16:
Lg14:
Lnohalo0:
s_waitcnt vmcnt(0)
s_waitcnt lgkmcnt(0)
s_barrier
s_lshl_b32 s59, s44, 2
s_lshl_b32 s51, s46, 0
s_add_u32 s59, s59, s51
s_sub_i32 s59, s59, 8
s_cmp_lt_i32 s59, 0
s_cbranch_scc1 Lnohalo
s_lshl_b32 s58, s59, 16
s_lshl_b32 s51, s45, 12
s_add_u32 s58, s58, s51
s_add_u32 s58, s58, 1048576
buffer_load_dwordx4 v[64:67], v1, s[32:35], s58 offen offset:0 sc1
buffer_load_dwordx4 v[68:71], v1, s[32:35], s58 offen offset:1024 sc1
buffer_load_dwordx4 v[72:75], v1, s[32:35], s58 offen offset:2048 sc1
buffer_load_dwordx4 v[76:79], v1, s[32:35], s58 offen offset:3072 sc1
Lnohalo:
s_cmp_lt_i32 s59, 0
s_cbranch_scc1 Lnohalo2
s_lshl_b32 s49, s46, 11
v_add_u32 v6, s49, v1
s_mul_i32 s49, s46, 2080
s_add_u32 s49, s49, 24576
v_add_u32 v7, s49, v1
s_waitcnt vmcnt(3)
ds_write_b128 v6, v[64:67] offset:0
s_waitcnt vmcnt(2)
ds_write_b128 v6, v[68:71] offset:1024
s_waitcnt vmcnt(1)
ds_write_b128 v7, v[72:75] offset:0
s_waitcnt vmcnt(0)
ds_write_b128 v7, v[76:79] offset:1040
Lnohalo2:
s_waitcnt lgkmcnt(0)
s_barrier
s_lshl_b32 s58, s63, 5
s_add_u32 s58, s58, 8192
s_cmp_lg_u32 s46, 1
s_cbranch_scc1 Lnopub2
v_and_b32 v6, 16, v1
v_add_u32 v7, 163456, v6
ds_read_b128 v[64:67], v7 offset:0
ds_read_b128 v[68:71], v7 offset:32
ds_read_b128 v[72:75], v7 offset:64
ds_read_b128 v[76:79], v7 offset:96
ds_read_b128 v[80:83], v7 offset:128
ds_read_b128 v[84:87], v7 offset:160
ds_read_b128 v[88:91], v7 offset:192
ds_read_b128 v[92:95], v7 offset:224
s_waitcnt lgkmcnt(0)
v_add_f32 v64, v64, v80
v_add_f32 v65, v65, v81
v_add_f32 v66, v66, v82
v_add_f32 v67, v67, v83
v_add_f32 v68, v68, v84
v_add_f32 v69, v69, v85
v_add_f32 v70, v70, v86
v_add_f32 v71, v71, v87
v_add_f32 v72, v72, v88
v_add_f32 v73, v73, v89
v_add_f32 v74, v74, v90
v_add_f32 v75, v75, v91
v_add_f32 v76, v76, v92
v_add_f32 v77, v77, v93
v_add_f32 v78, v78, v94
v_add_f32 v79, v79, v95
v_add_f32 v64, v64, v72
v_add_f32 v65, v65, v73
v_add_f32 v66, v66, v74
v_add_f32 v67, v67, v75
v_add_f32 v68, v68, v76
v_add_f32 v69, v69, v77
v_add_f32 v70, v70, v78
v_add_f32 v71, v71, v79
v_add_f32 v64, v64, v68
v_add_f32 v65, v65, v69
v_add_f32 v66, v66, v70
v_add_f32 v67, v67, v71
v_cvt_pk_bf16_f32 v64, v64, v65
v_cvt_pk_bf16_f32 v66, v66, v67
v_mov_b32 v65, s47
v_mov_b32 v67, s47
s_mov_b64 exec, 3
buffer_store_dwordx4 v[64:67], v6, s[32:35], s58 offen sc1
s_mov_b64 exec, -1
Lnopub2:
s_cmp_ge_u32 s44, 2
s_cbranch_scc1 Lnofix
s_lshl_b32 s49, s44, 2
s_sub_u32 s49, 8, s49
s_cmp_ge_u32 s46, s49
s_cbranch_scc1 Lfix1
s_lshl_b32 s49, s49, 11
v_lshrrev_b32 v6, 9, v1
v_lshlrev_b32 v6, 9, v6
v_add_u32 v6, s49, v6
ds_read_b128 v[64:67], v6
ds_read_b128 v[68:71], v6 offset:1024
v_mov_b32 v72, 0
v_mov_b32 v73, 0
v_mov_b32 v74, 0
v_mov_b32 v75, 0
s_lshl_b32 s49, s46, 11
v_add_u32 v6, s49, v1
s_mul_i32 s49, s46, 2080
s_add_u32 s49, s49, 24576
v_add_u32 v7, s49, v1
s_waitcnt lgkmcnt(0)
ds_write_b128 v6, v[64:67]
ds_write_b128 v6, v[68:71] offset:1024
ds_write_b128 v7, v[72:75]
ds_write_b128 v7, v[72:75] offset:1040
Lfix1:
s_waitcnt lgkmcnt(0)
s_barrier
Lnofix:
ds_read_b128 v[24:27], v18 offset:0
ds_read_b128 v[28:31], v18 offset:2048
ds_read_b128 v[32:35], v18 offset:4096
ds_read_b128 v[36:39], v18 offset:6144
ds_read_b128 v[40:43], v18 offset:8192
ds_read_b128 v[44:47], v18 offset:10240
ds_read_b128 v[48:51], v18 offset:12288
ds_read_b128 v[52:55], v18 offset:14336
ds_read_b128 v[56:59], v18 offset:16384
v_lshrrev_b32 v6, 8, v1
v_mul_u32_u24 v6, 2752, v6
v_and_b32 v7, 0xf0, v1
v_lshlrev_b32 v7, 3, v7
v_min_u32 v7, 1535, v7
v_add_u32 v6, v6, v7
s_and_b32 s50, s61, 1
s_mul_i32 s49, s60, 44032
s_mul_i32 s51, s62, 11008
s_add_u32 s49, s49, s51
s_mul_i32 s51, s50, 1536
s_add_u32 s49, s49, s51
s_cmp_eq_u32 s56, 1
s_cselect_b32 s36, s20, s16
s_cselect_b32 s37, s21, s17
s_mov_b32 s38, s18
s_mov_b32 s39, s19
buffer_load_dword v23, v6, s[36:39], s49 offen
v_lshrrev_b32 v6, 6, v1
v_and_b32 v7, 3, v6
v_bfe_u32 v5, v6, 2, 1
v_lshl_add_u32 v7, v5, 3, v7
v_lshrrev_b32 v6, 3, v6
v_lshl_add_u32 v6, v6, 2, v7
v_mul_u32_u24 v6, 2752, v6
v_and_b32 v7, 48, v1
v_add_u32 v5, v6, v7
s_and_b32 s49, s46, 1
s_cmp_eq_u32 s49, 1
s_cselect_b32 s36, s20, s16
s_cselect_b32 s37, s21, s17
s_mul_i32 s50, s45, 3
s_lshl_b32 s51, s45, 1
s_add_u32 s51, s51, 11
s_cmp_lt_u32 s45, 11
s_cselect_b32 s40, s50, s51
s_cselect_b32 s43, 128, 0
s_and_b32 s50, s1, 1
s_lshl_b32 s41, s40, 6
s_mul_i32 s51, s50, 704512
s_add_u32 s41, s41, s51
s_mul_i32 s51, s56, 44032
s_add_u32 s41, s41, s51
s_add_u32 s43, s43, s41
s_lshl_b32 s42, s56, 12
s_lshl_b32 s51, s50, 11
s_add_u32 s42, s42, s51
s_lshl_b32 s51, s49, 10
s_add_u32 s42, s42, s51
s_waitcnt lgkmcnt(0)
v_mfma_f32_32x32x16_bf16 v[64:79], v[24:27], v[12:15], 0
v_mfma_f32_32x32x16_bf16 v[80:95], v[56:59], v[12:15], 0
v_mfma_f32_32x32x16_bf16 v[96:111], v[28:31], v[12:15], 0
v_mfma_f32_32x32x16_bf16 v[112:127], v[32:35], v[12:15], 0
s_nop 9
v_cndmask_b32 v128, v64, v80, s[64:65]
v_cndmask_b32 v129, v65, v81, s[66:67]
v_cndmask_b32 v130, v66, v82, s[68:69]
v_cndmask_b32 v131, v67, v83, s[70:71]
v_cndmask_b32 v132, v68, v84, s[72:73]
v_cndmask_b32 v133, v69, v85, s[74:75]
v_cndmask_b32 v134, v70, v86, s[76:77]
v_cndmask_b32 v135, v71, v87, s[78:79]
v_cndmask_b32 v136, v72, v88, s[80:81]
v_cndmask_b32 v137, v73, v89, s[82:83]
v_cndmask_b32 v138, v74, v90, s[84:85]
v_cndmask_b32 v139, v75, v91, s[86:87]
v_cndmask_b32 v140, v76, v92, s[88:89]
v_cndmask_b32 v141, v77, v93, s[90:91]
v_cndmask_b32 v142, v78, v94, s[92:93]
v_cndmask_b32 v143, v79, v95, s[94:95]
v_mfma_f32_32x32x16_bf16 v[64:79], v[36:39], v[12:15], 0
v_max_f32 v216, v128, v129
v_max_f32 v217, v130, v131
v_max3_f32 v216, v132, v133, v216
v_max3_f32 v217, v134, v135, v217
v_max3_f32 v216, v136, v137, v216
v_max3_f32 v217, v138, v139, v217
v_max3_f32 v216, v140, v141, v216
v_max3_f32 v217, v142, v143, v217
v_mfma_f32_32x32x16_bf16 v[80:95], v[40:43], v[12:15], 0
v_max3_f32 v216, v96, v97, v216
v_max3_f32 v217, v98, v99, v217
v_max3_f32 v216, v100, v101, v216
v_max3_f32 v217, v102, v103, v217
v_max3_f32 v216, v104, v105, v216
v_max3_f32 v217, v106, v107, v217
v_max3_f32 v216, v108, v109, v216
v_max3_f32 v217, v110, v111, v217
v_mfma_f32_32x32x16_bf16 v[96:111], v[44:47], v[12:15], 0
v_max3_f32 v216, v112, v113, v216
v_max3_f32 v217, v114, v115, v217
v_max3_f32 v216, v116, v117, v216
v_max3_f32 v217, v118, v119, v217
v_max3_f32 v216, v120, v121, v216
v_max3_f32 v217, v122, v123, v217
v_max3_f32 v216, v124, v125, v216
v_max3_f32 v217, v126, v127, v217
v_mfma_f32_32x32x16_bf16 v[112:127], v[48:51], v[12:15], 0
v_max3_f32 v216, v64, v65, v216
v_max3_f32 v217, v66, v67, v217
v_max3_f32 v216, v68, v69, v216
v_max3_f32 v217, v70, v71, v217
v_max3_f32 v216, v72, v73, v216
v_max3_f32 v217, v74, v75, v217
v_max3_f32 v216, v76, v77, v216
v_max3_f32 v217, v78, v79, v217
v_mfma_f32_32x32x16_bf16 v[64:79], v[52:55], v[12:15], 0
v_max3_f32 v216, v80, v81, v216
v_max3_f32 v217, v82, v83, v217
v_max3_f32 v216, v84, v85, v216
v_max3_f32 v217, v86, v87, v217
v_max3_f32 v216, v88, v89, v216
v_max3_f32 v217, v90, v91, v217
v_max3_f32 v216, v92, v93, v216
v_max3_f32 v217, v94, v95, v217
v_max3_f32 v216, v96, v97, v216
v_max3_f32 v217, v98, v99, v217
v_max3_f32 v216, v100, v101, v216
v_max3_f32 v217, v102, v103, v217
v_max3_f32 v216, v104, v105, v216
v_max3_f32 v217, v106, v107, v217
v_max3_f32 v216, v108, v109, v216
v_max3_f32 v217, v110, v111, v217
v_max3_f32 v216, v112, v113, v216
v_max3_f32 v217, v114, v115, v217
v_max3_f32 v216, v116, v117, v216
v_max3_f32 v217, v118, v119, v217
v_max3_f32 v216, v120, v121, v216
v_max3_f32 v217, v122, v123, v217
v_max3_f32 v216, v124, v125, v216
v_max3_f32 v217, v126, v127, v217
v_max3_f32 v216, v64, v65, v216
v_max3_f32 v217, v66, v67, v217
v_max3_f32 v216, v68, v69, v216
v_max3_f32 v217, v70, v71, v217
v_max3_f32 v216, v72, v73, v216
v_max3_f32 v217, v74, v75, v217
v_max3_f32 v216, v76, v77, v216
v_max3_f32 v217, v78, v79, v217
v_max_f32 v216, v216, v217
v_mov_b32 v217, v216
s_nop 1
v_permlane32_swap_b32 v216, v217
v_max_f32 v216, v216, v217
v_sub_f32 v144, 0, v216
v_sub_f32 v145, 0, v216
v_sub_f32 v146, 0, v216
v_sub_f32 v147, 0, v216
v_sub_f32 v148, 0, v216
v_sub_f32 v149, 0, v216
v_sub_f32 v150, 0, v216
v_sub_f32 v151, 0, v216
v_sub_f32 v152, 0, v216
v_sub_f32 v153, 0, v216
v_sub_f32 v154, 0, v216
v_sub_f32 v155, 0, v216
v_sub_f32 v156, 0, v216
v_sub_f32 v157, 0, v216
v_sub_f32 v158, 0, v216
v_sub_f32 v159, 0, v216
s_nop 1
v_mfma_f32_32x32x16_bf16 v[96:111], v[28:31], v[12:15], v[144:159]
ds_read_b128 v[176:179], v20 offset:0
ds_read_b128 v[180:183], v20 offset:1040
ds_read_b128 v[184:187], v20 offset:16640
ds_read_b128 v[188:191], v20 offset:17680
v_mfma_f32_32x32x16_bf16 v[112:127], v[32:35], v[12:15], v[144:159]
v_add_f32 v128, v128, v144
v_add_f32 v129, v129, v145
v_add_f32 v130, v130, v146
v_add_f32 v131, v131, v147
v_add_f32 v132, v132, v148
v_add_f32 v133, v133, v149
v_add_f32 v134, v134, v150
v_add_f32 v135, v135, v151
v_add_f32 v136, v136, v152
v_add_f32 v137, v137, v153
v_add_f32 v138, v138, v154
v_add_f32 v139, v139, v155
v_add_f32 v140, v140, v156
v_add_f32 v141, v141, v157
v_add_f32 v142, v142, v158
v_add_f32 v143, v143, v159
v_exp_f32 v128, v128
v_exp_f32 v129, v129
v_exp_f32 v130, v130
v_exp_f32 v131, v131
v_exp_f32 v132, v132
v_exp_f32 v133, v133
v_exp_f32 v134, v134
v_exp_f32 v135, v135
v_exp_f32 v136, v136
v_exp_f32 v137, v137
v_exp_f32 v138, v138
v_exp_f32 v139, v139
v_exp_f32 v140, v140
v_exp_f32 v141, v141
v_exp_f32 v142, v142
v_exp_f32 v143, v143
v_cvt_pk_bf16_f32 v160, v128, v129
v_cvt_pk_bf16_f32 v161, v130, v131
v_cvt_pk_bf16_f32 v162, v132, v133
v_cvt_pk_bf16_f32 v163, v134, v135
v_cvt_pk_bf16_f32 v164, v136, v137
v_cvt_pk_bf16_f32 v165, v138, v139
v_cvt_pk_bf16_f32 v166, v140, v141
v_cvt_pk_bf16_f32 v167, v142, v143
v_and_b32 v168, v208, v160
v_xor_b32 v160, v160, v168
v_and_b32 v169, v209, v161
v_xor_b32 v161, v161, v169
v_and_b32 v170, v210, v162
v_xor_b32 v162, v162, v170
v_and_b32 v171, v211, v163
v_xor_b32 v163, v163, v171
v_and_b32 v172, v212, v164
v_xor_b32 v164, v164, v172
v_and_b32 v173, v213, v165
v_xor_b32 v165, v165, v173
v_and_b32 v174, v214, v166
v_xor_b32 v166, v166, v174
v_and_b32 v175, v215, v167
v_xor_b32 v167, v167, v175
s_waitcnt lgkmcnt(0)
v_mfma_f32_32x32x16_bf16 v[192:207], v[176:179], v[160:163], 0
v_mfma_f32_32x32x16_bf16 v[192:207], v[180:183], v[164:167], v[192:207]
v_mfma_f32_32x32x16_bf16 v[192:207], v[184:187], v[168:171], v[192:207]
v_mfma_f32_32x32x16_bf16 v[192:207], v[188:191], v[172:175], v[192:207]
ds_read_b128 v[176:179], v20 offset:2080
ds_read_b128 v[180:183], v20 offset:3120
v_mfma_f32_32x32x16_bf16 v[64:79], v[36:39], v[12:15], v[144:159]
v_exp_f32 v96, v96
v_exp_f32 v97, v97
v_exp_f32 v98, v98
v_exp_f32 v99, v99
v_exp_f32 v100, v100
v_exp_f32 v101, v101
v_exp_f32 v102, v102
v_exp_f32 v103, v103
v_exp_f32 v104, v104
v_exp_f32 v105, v105
v_exp_f32 v106, v106
v_exp_f32 v107, v107
v_exp_f32 v108, v108
v_exp_f32 v109, v109
v_exp_f32 v110, v110
v_exp_f32 v111, v111
v_cvt_pk_bf16_f32 v160, v96, v97
v_cvt_pk_bf16_f32 v161, v98, v99
v_cvt_pk_bf16_f32 v162, v100, v101
v_cvt_pk_bf16_f32 v163, v102, v103
v_cvt_pk_bf16_f32 v164, v104, v105
v_cvt_pk_bf16_f32 v165, v106, v107
v_cvt_pk_bf16_f32 v166, v108, v109
v_cvt_pk_bf16_f32 v167, v110, v111
s_waitcnt lgkmcnt(0)
v_mfma_f32_32x32x16_bf16 v[192:207], v[176:179], v[160:163], v[192:207]
v_mfma_f32_32x32x16_bf16 v[192:207], v[180:183], v[164:167], v[192:207]
ds_read_b128 v[184:187], v20 offset:4160
ds_read_b128 v[188:191], v20 offset:5200
v_mfma_f32_32x32x16_bf16 v[80:95], v[40:43], v[12:15], v[144:159]
v_exp_f32 v112, v112
v_exp_f32 v113, v113
v_exp_f32 v114, v114
v_exp_f32 v115, v115
v_exp_f32 v116, v116
v_exp_f32 v117, v117
v_exp_f32 v118, v118
v_exp_f32 v119, v119
v_exp_f32 v120, v120
v_exp_f32 v121, v121
v_exp_f32 v122, v122
v_exp_f32 v123, v123
v_exp_f32 v124, v124
v_exp_f32 v125, v125
v_exp_f32 v126, v126
v_exp_f32 v127, v127
v_cvt_pk_bf16_f32 v168, v112, v113
v_cvt_pk_bf16_f32 v169, v114, v115
v_cvt_pk_bf16_f32 v170, v116, v117
v_cvt_pk_bf16_f32 v171, v118, v119
v_cvt_pk_bf16_f32 v172, v120, v121
v_cvt_pk_bf16_f32 v173, v122, v123
v_cvt_pk_bf16_f32 v174, v124, v125
v_cvt_pk_bf16_f32 v175, v126, v127
s_waitcnt lgkmcnt(0)
v_mfma_f32_32x32x16_bf16 v[192:207], v[184:187], v[168:171], v[192:207]
v_mfma_f32_32x32x16_bf16 v[192:207], v[188:191], v[172:175], v[192:207]
ds_read_b128 v[176:179], v20 offset:6240
ds_read_b128 v[180:183], v20 offset:7280
v_mfma_f32_32x32x16_bf16 v[96:111], v[44:47], v[12:15], v[144:159]
s_add_u32 m0, s42, 115712
s_add_u32 s49, s41, 0
buffer_load_dwordx4 v5, s[36:39], s49 offen lds
v_exp_f32 v64, v64
v_exp_f32 v65, v65
v_exp_f32 v66, v66
v_exp_f32 v67, v67
v_exp_f32 v68, v68
v_exp_f32 v69, v69
v_exp_f32 v70, v70
v_exp_f32 v71, v71
v_exp_f32 v72, v72
v_exp_f32 v73, v73
v_exp_f32 v74, v74
v_exp_f32 v75, v75
v_exp_f32 v76, v76
v_exp_f32 v77, v77
v_exp_f32 v78, v78
v_exp_f32 v79, v79
v_cvt_pk_bf16_f32 v160, v64, v65
v_cvt_pk_bf16_f32 v161, v66, v67
v_cvt_pk_bf16_f32 v162, v68, v69
v_cvt_pk_bf16_f32 v163, v70, v71
v_cvt_pk_bf16_f32 v164, v72, v73
v_cvt_pk_bf16_f32 v165, v74, v75
v_cvt_pk_bf16_f32 v166, v76, v77
v_cvt_pk_bf16_f32 v167, v78, v79
s_waitcnt lgkmcnt(0)
v_mfma_f32_32x32x16_bf16 v[192:207], v[176:179], v[160:163], v[192:207]
v_mfma_f32_32x32x16_bf16 v[192:207], v[180:183], v[164:167], v[192:207]
ds_read_b128 v[184:187], v20 offset:8320
ds_read_b128 v[188:191], v20 offset:9360
v_mfma_f32_32x32x16_bf16 v[112:127], v[48:51], v[12:15], v[144:159]
s_add_u32 m0, s42, 123904
s_add_u32 s49, s41, 88064
buffer_load_dwordx4 v5, s[36:39], s49 offen lds
v_exp_f32 v80, v80
v_exp_f32 v81, v81
v_exp_f32 v82, v82
v_exp_f32 v83, v83
v_exp_f32 v84, v84
v_exp_f32 v85, v85
v_exp_f32 v86, v86
v_exp_f32 v87, v87
v_exp_f32 v88, v88
v_exp_f32 v89, v89
v_exp_f32 v90, v90
v_exp_f32 v91, v91
v_exp_f32 v92, v92
v_exp_f32 v93, v93
v_exp_f32 v94, v94
v_exp_f32 v95, v95
v_cvt_pk_bf16_f32 v168, v80, v81
v_cvt_pk_bf16_f32 v169, v82, v83
v_cvt_pk_bf16_f32 v170, v84, v85
v_cvt_pk_bf16_f32 v171, v86, v87
v_cvt_pk_bf16_f32 v172, v88, v89
v_cvt_pk_bf16_f32 v173, v90, v91
v_cvt_pk_bf16_f32 v174, v92, v93
v_cvt_pk_bf16_f32 v175, v94, v95
s_waitcnt lgkmcnt(0)
v_mfma_f32_32x32x16_bf16 v[192:207], v[184:187], v[168:171], v[192:207]
v_mfma_f32_32x32x16_bf16 v[192:207], v[188:191], v[172:175], v[192:207]
ds_read_b128 v[176:179], v20 offset:10400
ds_read_b128 v[180:183], v20 offset:11440
v_mfma_f32_32x32x16_bf16 v[64:79], v[52:55], v[12:15], v[144:159]
s_add_u32 m0, s42, 132096
s_add_u32 s49, s41, 176128
buffer_load_dwordx4 v5, s[36:39], s49 offen lds
v_exp_f32 v96, v96
v_exp_f32 v97, v97
v_exp_f32 v98, v98
v_exp_f32 v99, v99
v_exp_f32 v100, v100
v_exp_f32 v101, v101
v_exp_f32 v102, v102
v_exp_f32 v103, v103
v_exp_f32 v104, v104
v_exp_f32 v105, v105
v_exp_f32 v106, v106
v_exp_f32 v107, v107
v_exp_f32 v108, v108
v_exp_f32 v109, v109
v_exp_f32 v110, v110
v_exp_f32 v111, v111
v_cvt_pk_bf16_f32 v160, v96, v97
v_cvt_pk_bf16_f32 v161, v98, v99
v_cvt_pk_bf16_f32 v162, v100, v101
v_cvt_pk_bf16_f32 v163, v102, v103
v_cvt_pk_bf16_f32 v164, v104, v105
v_cvt_pk_bf16_f32 v165, v106, v107
v_cvt_pk_bf16_f32 v166, v108, v109
v_cvt_pk_bf16_f32 v167, v110, v111
s_waitcnt lgkmcnt(0)
v_mfma_f32_32x32x16_bf16 v[192:207], v[176:179], v[160:163], v[192:207]
v_mfma_f32_32x32x16_bf16 v[192:207], v[180:183], v[164:167], v[192:207]
ds_read_b128 v[184:187], v20 offset:12480
ds_read_b128 v[188:191], v20 offset:13520
s_add_u32 m0, s42, 140288
s_add_u32 s49, s41, 264192
buffer_load_dwordx4 v5, s[36:39], s49 offen lds
v_exp_f32 v112, v112
v_exp_f32 v113, v113
v_exp_f32 v114, v114
v_exp_f32 v115, v115
v_exp_f32 v116, v116
v_exp_f32 v117, v117
v_exp_f32 v118, v118
v_exp_f32 v119, v119
v_exp_f32 v120, v120
v_exp_f32 v121, v121
v_exp_f32 v122, v122
v_exp_f32 v123, v123
v_exp_f32 v124, v124
v_exp_f32 v125, v125
v_exp_f32 v126, v126
v_exp_f32 v127, v127
v_cvt_pk_bf16_f32 v168, v112, v113
v_cvt_pk_bf16_f32 v169, v114, v115
v_cvt_pk_bf16_f32 v170, v116, v117
v_cvt_pk_bf16_f32 v171, v118, v119
v_cvt_pk_bf16_f32 v172, v120, v121
v_cvt_pk_bf16_f32 v173, v122, v123
v_cvt_pk_bf16_f32 v174, v124, v125
v_cvt_pk_bf16_f32 v175, v126, v127
s_waitcnt lgkmcnt(0)
v_mfma_f32_32x32x16_bf16 v[192:207], v[184:187], v[168:171], v[192:207]
v_mfma_f32_32x32x16_bf16 v[192:207], v[188:191], v[172:175], v[192:207]
ds_read_b128 v[176:179], v20 offset:14560
ds_read_b128 v[180:183], v20 offset:15600
s_add_u32 m0, s42, 148480
s_add_u32 s49, s41, 352256
buffer_load_dwordx4 v5, s[36:39], s49 offen lds
v_exp_f32 v64, v64
v_exp_f32 v65, v65
v_exp_f32 v66, v66
v_exp_f32 v67, v67
v_exp_f32 v68, v68
v_exp_f32 v69, v69
v_exp_f32 v70, v70
v_exp_f32 v71, v71
v_exp_f32 v72, v72
v_exp_f32 v73, v73
v_exp_f32 v74, v74
v_exp_f32 v75, v75
v_exp_f32 v76, v76
v_exp_f32 v77, v77
v_exp_f32 v78, v78
v_exp_f32 v79, v79
v_cvt_pk_bf16_f32 v160, v64, v65
v_cvt_pk_bf16_f32 v161, v66, v67
v_cvt_pk_bf16_f32 v162, v68, v69
v_cvt_pk_bf16_f32 v163, v70, v71
v_cvt_pk_bf16_f32 v164, v72, v73
v_cvt_pk_bf16_f32 v165, v74, v75
v_cvt_pk_bf16_f32 v166, v76, v77
v_cvt_pk_bf16_f32 v167, v78, v79
s_waitcnt lgkmcnt(0)
v_mfma_f32_32x32x16_bf16 v[192:207], v[176:179], v[160:163], v[192:207]
v_mfma_f32_32x32x16_bf16 v[192:207], v[180:183], v[164:167], v[192:207]
s_lshl_b32 s50, s48, 15
s_lshl_b32 s51, s45, 11
s_add_u32 s50, s50, s51
s_lshl_b32 s51, s56, 10
s_add_u32 s50, s50, s51
s_add_u32 s50, s50, 5242880
s_nop 5
v_rcp_f32 v6, v200
s_nop 0
v_mul_f32 v192, v6, v192
v_mul_f32 v193, v6, v193
v_cvt_pk_bf16_f32 v40, v192, v193
v_mul_f32 v194, v6, v194
v_mul_f32 v195, v6, v195
v_cvt_pk_bf16_f32 v41, v194, v195
v_mul_f32 v196, v6, v196
v_mul_f32 v197, v6, v197
v_cvt_pk_bf16_f32 v42, v196, v197
v_mul_f32 v198, v6, v198
v_mul_f32 v199, v6, v199
v_cvt_pk_bf16_f32 v43, v198, v199
buffer_store_dwordx4 v[40:43], v1, s[32:35], s50 offen sc1
s_waitcnt vmcnt(0)
s_waitcnt lgkmcnt(0)
s_barrier
s_cmp_lg_u32 s46, 7
s_cbranch_scc1 Ls17
s_lshl_b32 s58, s44, 5
s_lshl_b32 s51, s45, 0
s_add_u32 s58, s58, s51
s_lshl_b32 s50, s58, 2
s_add_u32 s50, s50, 40960
v_mov_b32 v6, s47
v_mov_b32 v7, 0
s_mov_b64 exec, 1
buffer_store_dword v6, v7, s[32:35], s50 offen sc1
s_mov_b64 exec, -1
Ls17:
s_cmp_lg_u32 s46, 1
s_cbranch_scc1 Lnm2
s_mov_b32 s50, 10240
v_lshlrev_b32 v26, 1, v1
s_lshl_b32 s100, s57, 8
s_add_u32 s100, s100, 8192
v_and_b32 v27, 0xf0, v1
v_and_b32 v6, 256, v1
v_mul_u32_u24 v6, 24, v6
v_add_u32 v27, v27, v6
s_mov_b32 s52, 400000
Lp18:
buffer_load_dwordx4 v[32:35], v26, s[32:35], s50 offen offset:0 sc1
buffer_load_dwordx4 v[36:39], v26, s[32:35], s50 offen offset:16 sc1
buffer_load_dwordx4 v[40:43], v26, s[32:35], s50 offen offset:2048 sc1
buffer_load_dwordx4 v[44:47], v26, s[32:35], s50 offen offset:2064 sc1
buffer_load_dwordx4 v[64:67], v27, s[32:35], s100 offen sc1
s_waitcnt vmcnt(0)
v_cmp_ne_u32 vcc, s47, v33
v_cmp_ne_u32 s[98:99], s47, v35
s_nop 1
s_or_b64 vcc, vcc, s[98:99]
v_cmp_ne_u32 s[98:99], s47, v37
s_nop 1
s_or_b64 vcc, vcc, s[98:99]
v_cmp_ne_u32 s[98:99], s47, v39
s_nop 1
s_or_b64 vcc, vcc, s[98:99]
v_cmp_ne_u32 s[98:99], s47, v41
s_nop 1
s_or_b64 vcc, vcc, s[98:99]
v_cmp_ne_u32 s[98:99], s47, v43
s_nop 1
s_or_b64 vcc, vcc, s[98:99]
v_cmp_ne_u32 s[98:99], s47, v45
s_nop 1
s_or_b64 vcc, vcc, s[98:99]
v_cmp_ne_u32 s[98:99], s47, v47
s_nop 1
s_or_b64 vcc, vcc, s[98:99]
v_cmp_ne_u32 s[98:99], s47, v65
s_nop 1
s_or_b64 vcc, vcc, s[98:99]
v_cmp_ne_u32 s[98:99], s47, v67
s_nop 1
s_or_b64 vcc, vcc, s[98:99]
s_nop 0
s_cbranch_vccz Ld19
s_sub_u32 s52, s52, 1
s_cmp_lg_u32 s52, 0
s_cbranch_scc1 Lp18
Ld19:
v_lshlrev_b32 v56, 16, v32
v_and_b32 v57, s54, v32
v_lshlrev_b32 v48, 16, v40
v_and_b32 v49, s54, v40
v_lshlrev_b32 v58, 16, v34
v_and_b32 v59, s54, v34
v_lshlrev_b32 v50, 16, v42
v_and_b32 v51, s54, v42
v_lshlrev_b32 v60, 16, v36
v_and_b32 v61, s54, v36
v_lshlrev_b32 v52, 16, v44
v_and_b32 v53, s54, v44
v_lshlrev_b32 v62, 16, v38
v_and_b32 v63, s54, v38
v_lshlrev_b32 v54, 16, v46
v_and_b32 v55, s54, v46
v_add_f32 v48, 1.0, v48
v_add_f32 v49, 1.0, v49
v_cvt_pk_bf16_f32 v49, v48, v49
v_lshlrev_b32 v48, 16, v49
v_and_b32 v49, s54, v49
v_add_f32 v50, 1.0, v50
v_add_f32 v51, 1.0, v51
v_cvt_pk_bf16_f32 v51, v50, v51
v_lshlrev_b32 v50, 16, v51
v_and_b32 v51, s54, v51
v_add_f32 v52, 1.0, v52
v_add_f32 v53, 1.0, v53
v_cvt_pk_bf16_f32 v53, v52, v53
v_lshlrev_b32 v52, 16, v53
v_and_b32 v53, s54, v53
v_add_f32 v54, 1.0, v54
v_add_f32 v55, 1.0, v55
v_cvt_pk_bf16_f32 v55, v54, v55
v_lshlrev_b32 v54, 16, v55
v_and_b32 v55, s54, v55
v_lshrrev_b32 v6, 5, v1
v_lshlrev_b32 v6, 7, v6
v_and_b32 v7, 16, v1
v_add_u32 v6, v6, v7
v_add_u32 v6, 159232, v6
ds_write_b128 v6, v[48:51] offset:0
ds_write_b128 v6, v[52:55] offset:64
ds_write_b128 v6, v[56:59] offset:32
ds_write_b128 v6, v[60:63] offset:96
v_lshlrev_b32 v36, 16, v64
v_and_b32 v37, s54, v64
v_lshlrev_b32 v38, 16, v66
v_and_b32 v39, s54, v66
v_and_b32 v6, 0x1f0, v1
v_add_u32 v6, 163328, v6
ds_write_b128 v6, v[36:39]
Lnm2:
s_add_u32 m0, s42, 0
s_add_u32 s49, s41, 440320
buffer_load_dwordx4 v5, s[36:39], s49 offen lds
s_add_u32 m0, s42, 8192
s_add_u32 s49, s41, 528384
buffer_load_dwordx4 v5, s[36:39], s49 offen lds
s_add_u32 m0, s42, 16384
s_add_u32 s49, s41, 616448
buffer_load_dwordx4 v5, s[36:39], s49 offen lds
s_add_u32 m0, s42, 24576
s_add_u32 s49, s41, 64
buffer_load_dwordx4 v5, s[36:39], s49 offen lds
s_add_u32 m0, s42, 32768
s_add_u32 s49, s41, 88128
buffer_load_dwordx4 v5, s[36:39], s49 offen lds
s_add_u32 m0, s42, 40960
s_add_u32 s49, s41, 176192
buffer_load_dwordx4 v5, s[36:39], s49 offen lds
v_permlane32_swap_b32 v8, v10
v_permlane32_swap_b32 v9, v11
s_and_b32 s49, s1, 1
s_lshl_b32 s49, s49, 5
v_xor_b32 v6, s49, v2
s_lshl_b32 s49, s1, 14
s_lshl_b32 s51, s56, 10
s_add_u32 s49, s49, s51
s_add_u32 s49, s49, 50176
v_add_u32 v50, s49, v6
s_lshl_b32 s49, s56, 11
s_sub_u32 s49, 1024, s49
v_add_u32 v51, s49, v50
ds_read_b64_tr_b16 v[24:25], v50 offset:0
ds_read_b64_tr_b16 v[26:27], v50 offset:256
ds_read_b64_tr_b16 v[28:29], v51 offset:0
ds_read_b64_tr_b16 v[30:31], v51 offset:256
ds_read_b64_tr_b16 v[32:33], v50 offset:2048
ds_read_b64_tr_b16 v[34:35], v50 offset:2304
ds_read_b64_tr_b16 v[36:37], v51 offset:2048
ds_read_b64_tr_b16 v[38:39], v51 offset:2304
ds_read_b64_tr_b16 v[40:41], v50 offset:4096
ds_read_b64_tr_b16 v[42:43], v50 offset:4352
ds_read_b64_tr_b16 v[44:45], v51 offset:4096
ds_read_b64_tr_b16 v[46:47], v51 offset:4352
s_waitcnt lgkmcnt(0)
s_cmp_lg_u32 s46, 0
s_cbranch_scc1 Lg20
v_lshrrev_b32 v7, 2, v1
v_and_b32 v7, 60, v7
s_lshr_b32 s49, s55, 2
s_lshl_b32 s50, s49, 5
s_lshl_b32 s50, s50, 2
s_add_u32 s50, s50, 40960
s_mov_b32 s52, 400000
Lp21:
buffer_load_dword v22, v7, s[32:35], s50 offen sc1
s_waitcnt vmcnt(0)
v_cmp_ne_u32 vcc, s47, v22
s_nop 0
s_cbranch_vccz Ld22
s_sub_u32 s52, s52, 1
s_cmp_lg_u32 s52, 0
s_cbranch_scc1 Lp21
Ld22:
Lg20:
s_waitcnt vmcnt(0)
s_waitcnt lgkmcnt(0)
s_barrier
s_lshl_b32 s58, s55, 15
s_lshl_b32 s51, s1, 13
s_add_u32 s58, s58, s51
s_add_u32 s58, s58, 5242880
buffer_load_dwordx4 v[192:195], v1, s[32:35], s58 offen offset:0 sc1
buffer_load_dwordx4 v[196:199], v1, s[32:35], s58 offen offset:1024 sc1
buffer_load_dwordx4 v[200:203], v1, s[32:35], s58 offen offset:2048 sc1
buffer_load_dwordx4 v[204:207], v1, s[32:35], s58 offen offset:3072 sc1
s_waitcnt vmcnt(3)
v_mfma_f32_32x32x16_bf16 v[64:79], v[24:27], v[192:195], 0
s_add_u32 s58, s58, 4096
buffer_load_dwordx4 v[208:211], v1, s[32:35], s58 offen offset:0 sc1
v_mfma_f32_32x32x16_bf16 v[80:95], v[28:31], v[192:195], 0
s_waitcnt vmcnt(3)
v_mfma_f32_32x32x16_bf16 v[64:79], v[32:35], v[196:199], v[64:79]
ds_read_b64_tr_b16 v[24:25], v50 offset:6144
ds_read_b64_tr_b16 v[26:27], v50 offset:6400
ds_read_b64_tr_b16 v[28:29], v51 offset:6144
ds_read_b64_tr_b16 v[30:31], v51 offset:6400
buffer_load_dwordx4 v[212:215], v1, s[32:35], s58 offen offset:1024 sc1
v_mfma_f32_32x32x16_bf16 v[80:95], v[36:39], v[196:199], v[80:95]
s_waitcnt vmcnt(3)
v_mfma_f32_32x32x16_bf16 v[64:79], v[40:43], v[200:203], v[64:79]
ds_read_b64_tr_b16 v[32:33], v50 offset:8192
ds_read_b64_tr_b16 v[34:35], v50 offset:8448
ds_read_b64_tr_b16 v[36:37], v51 offset:8192
ds_read_b64_tr_b16 v[38:39], v51 offset:8448
buffer_load_dwordx4 v[216:219], v1, s[32:35], s58 offen offset:2048 sc1
v_mfma_f32_32x32x16_bf16 v[80:95], v[44:47], v[200:203], v[80:95]
s_waitcnt lgkmcnt(4)
s_waitcnt vmcnt(3)
v_mfma_f32_32x32x16_bf16 v[64:79], v[24:27], v[204:207], v[64:79]
ds_read_b64_tr_b16 v[40:41], v50 offset:10240
ds_read_b64_tr_b16 v[42:43], v50 offset:10496
ds_read_b64_tr_b16 v[44:45], v51 offset:10240
ds_read_b64_tr_b16 v[46:47], v51 offset:10496
buffer_load_dwordx4 v[220:223], v1, s[32:35], s58 offen offset:3072 sc1
v_mfma_f32_32x32x16_bf16 v[80:95], v[28:31], v[204:207], v[80:95]
s_waitcnt lgkmcnt(4)
s_waitcnt vmcnt(3)
v_mfma_f32_32x32x16_bf16 v[64:79], v[32:35], v[208:211], v[64:79]
ds_read_b64_tr_b16 v[24:25], v50 offset:12288
ds_read_b64_tr_b16 v[26:27], v50 offset:12544
ds_read_b64_tr_b16 v[28:29], v51 offset:12288
ds_read_b64_tr_b16 v[30:31], v51 offset:12544
v_mfma_f32_32x32x16_bf16 v[80:95], v[36:39], v[208:211], v[80:95]
s_waitcnt lgkmcnt(4)
s_waitcnt vmcnt(2)
v_mfma_f32_32x32x16_bf16 v[64:79], v[40:43], v[212:215], v[64:79]
ds_read_b64_tr_b16 v[32:33], v50 offset:14336
ds_read_b64_tr_b16 v[34:35], v50 offset:14592
ds_read_b64_tr_b16 v[36:37], v51 offset:14336
ds_read_b64_tr_b16 v[38:39], v51 offset:14592
v_mfma_f32_32x32x16_bf16 v[80:95], v[44:47], v[212:215], v[80:95]
s_waitcnt lgkmcnt(4)
s_waitcnt vmcnt(1)
v_mfma_f32_32x32x16_bf16 v[64:79], v[24:27], v[216:219], v[64:79]
v_mfma_f32_32x32x16_bf16 v[80:95], v[28:31], v[216:219], v[80:95]
s_waitcnt lgkmcnt(0)
s_waitcnt vmcnt(0)
v_mfma_f32_32x32x16_bf16 v[64:79], v[32:35], v[220:223], v[64:79]
v_mfma_f32_32x32x16_bf16 v[80:95], v[36:39], v[220:223], v[80:95]
s_xor_b32 s50, s46, 2
s_mul_i32 s49, s50, 6144
s_add_u32 s49, s49, 50176
v_add_u32 v43, s49, v1
s_xor_b32 s50, s46, 4
s_mul_i32 s49, s50, 6144
s_add_u32 s49, s49, 52224
v_add_u32 v44, s49, v1
s_xor_b32 s50, s46, 6
s_mul_i32 s49, s50, 6144
s_add_u32 s49, s49, 54272
v_add_u32 v45, s49, v1
s_mul_i32 s49, s46, 6144
s_add_u32 s49, s49, 50176
v_add_u32 v46, s49, v1
s_lshl_b32 s49, s1, 6
s_add_u32 s49, s49, 163328
v_lshrrev_b32 v6, 9, v1
v_lshlrev_b32 v6, 4, v6
v_add_u32 v6, s49, v6
ds_read_b128 v[120:123], v6 offset:0
ds_read_b128 v[124:127], v6 offset:32
s_barrier
ds_write_b128 v44, v[80:83] offset:0
ds_write_b128 v44, v[84:87] offset:1024
ds_write_b128 v45, v[88:91] offset:0
ds_write_b128 v45, v[92:95] offset:1024
ds_write_b128 v43, v[72:75] offset:0
ds_write_b128 v43, v[76:79] offset:1024
s_waitcnt lgkmcnt(0)
s_barrier
ds_read_b128 v[96:99], v46 offset:0
ds_read_b128 v[100:103], v46 offset:1024
ds_read_b128 v[104:107], v46 offset:2048
ds_read_b128 v[108:111], v46 offset:3072
ds_read_b128 v[112:115], v46 offset:4096
ds_read_b128 v[116:119], v46 offset:5120
v_lshlrev_b32 v24, 16, v8
v_and_b32 v25, s54, v8
v_lshlrev_b32 v26, 16, v9
v_and_b32 v27, s54, v9
v_lshlrev_b32 v28, 16, v10
v_and_b32 v29, s54, v10
v_lshlrev_b32 v30, 16, v11
v_and_b32 v31, s54, v11
s_waitcnt lgkmcnt(0)
v_add_f32 v96, v96, v104
v_add_f32 v64, v64, v112
v_add_f32 v97, v97, v105
v_add_f32 v65, v65, v113
v_add_f32 v98, v98, v106
v_add_f32 v66, v66, v114
v_add_f32 v99, v99, v107
v_add_f32 v67, v67, v115
v_add_f32 v100, v100, v108
v_add_f32 v68, v68, v116
v_add_f32 v101, v101, v109
v_add_f32 v69, v69, v117
v_add_f32 v102, v102, v110
v_add_f32 v70, v70, v118
v_add_f32 v103, v103, v111
v_add_f32 v71, v71, v119
v_add_f32 v64, v64, v96
v_add_f32 v65, v65, v97
v_add_f32 v66, v66, v98
v_add_f32 v67, v67, v99
v_add_f32 v68, v68, v100
v_add_f32 v69, v69, v101
v_add_f32 v70, v70, v102
v_add_f32 v71, v71, v103
v_fmac_f32 v24, v64, v120
v_fmac_f32 v25, v65, v121
v_fmac_f32 v26, v66, v122
v_fmac_f32 v27, v67, v123
v_fmac_f32 v28, v68, v124
v_fmac_f32 v29, v69, v125
v_fmac_f32 v30, v70, v126
v_fmac_f32 v31, v71, v127
v_cvt_pk_bf16_f32 v8, v24, v25
v_cvt_pk_bf16_f32 v9, v26, v27
v_cvt_pk_bf16_f32 v10, v28, v29
v_cvt_pk_bf16_f32 v11, v30, v31
s_lshl_b32 s58, s55, 15
s_lshl_b32 s51, s57, 12
s_add_u32 s58, s58, s51
s_lshl_b32 s51, s1, 10
s_add_u32 s58, s58, s51
s_add_u32 s58, s58, 7340032
buffer_store_dwordx4 v[8:11], v1, s[32:35], s58 offen sc1
v_add_f32 v32, v24, v25
v_mul_f32 v33, v24, v24
v_fmac_f32 v33, v25, v25
v_add_f32 v32, v32, v26
v_fmac_f32 v33, v26, v26
v_add_f32 v32, v32, v27
v_fmac_f32 v33, v27, v27
v_add_f32 v32, v32, v28
v_fmac_f32 v33, v28, v28
v_add_f32 v32, v32, v29
v_fmac_f32 v33, v29, v29
v_add_f32 v32, v32, v30
v_fmac_f32 v33, v30, v30
v_add_f32 v32, v32, v31
v_fmac_f32 v33, v31, v31
v_mov_b32 v34, v32
s_nop 1
v_permlane32_swap_b32 v32, v34
v_add_f32 v32, v32, v34
v_mov_b32 v34, v33
s_nop 1
v_permlane32_swap_b32 v33, v34
v_add_f32 v33, v33, v34
s_and_b32 s50, s46, 1
s_lshl_b32 s49, s50, 10
s_add_u32 s49, s49, 99328
v_lshrrev_b32 v6, 1, v1
v_and_b32 v6, 0xf8, v6
v_add_u32 v7, s49, v6
s_lshl_b32 s50, s1, 8
v_add_u32 v16, s50, v7
ds_write_b64 v16, v[32:33] offset:0
s_waitcnt lgkmcnt(0)
s_barrier
s_cmp_lg_u32 s1, 0
s_cbranch_scc1 Lnost
ds_read_b64 v[32:33], v7 offset:0
ds_read_b64 v[34:35], v7 offset:256
ds_read_b64 v[36:37], v7 offset:512
ds_read_b64 v[38:39], v7 offset:768
s_lshr_b32 s50, s57, 1
s_and_b32 s59, s57, 1
s_lshl_b32 s58, s55, 11
s_lshl_b32 s51, s50, 9
s_add_u32 s58, s58, s51
s_lshl_b32 s51, s59, 3
s_add_u32 s58, s58, s51
s_add_u32 s58, s58, 65536
v_lshlrev_b32 v6, 1, v6
s_waitcnt lgkmcnt(0)
v_add_f32 v32, v32, v34
v_add_f32 v33, v33, v35
v_add_f32 v36, v36, v38
v_add_f32 v37, v37, v39
v_add_f32 v32, v32, v36
v_add_f32 v33, v33, v37
buffer_store_dwordx2 v[32:33], v6, s[32:35], s58 offen sc1
Lnost:
s_waitcnt vmcnt(0)
s_waitcnt lgkmcnt(0)
s_barrier
s_cmp_lg_u32 s46, 7
s_cbranch_scc1 Ls23
s_lshr_b32 s49, s55, 2
s_bfe_u32 s50, s55, 0x10001
s_lshl_b32 s58, s49, 5
s_lshl_b32 s51, s57, 1
s_add_u32 s58, s58, s51
s_lshl_b32 s51, s50, 0
s_add_u32 s58, s58, s51
s_lshl_b32 s50, s58, 2
s_add_u32 s50, s50, 49152
v_mov_b32 v6, s47
v_mov_b32 v7, 0
s_mov_b64 exec, 1
buffer_store_dword v6, v7, s[32:35], s50 offen sc1
s_mov_b64 exec, -1
Ls23:
s_add_u32 m0, s42, 50176
s_add_u32 s49, s41, 264256
buffer_load_dwordx4 v5, s[36:39], s49 offen lds
s_add_u32 m0, s42, 58368
s_add_u32 s49, s41, 352320
buffer_load_dwordx4 v5, s[36:39], s49 offen lds
s_add_u32 m0, s42, 66560
s_add_u32 s49, s41, 440384
buffer_load_dwordx4 v5, s[36:39], s49 offen lds
s_add_u32 m0, s42, 74752
s_add_u32 s49, s41, 528448
buffer_load_dwordx4 v5, s[36:39], s49 offen lds
s_add_u32 m0, s42, 82944
s_add_u32 s49, s41, 616512
buffer_load_dwordx4 v5, s[36:39], s49 offen lds
s_add_u32 m0, s42, 91136
s_add_u32 s49, s43, 0
buffer_load_dwordx4 v5, s[36:39], s49 offen lds
s_add_u32 m0, s42, 99328
s_add_u32 s49, s43, 88064
buffer_load_dwordx4 v5, s[36:39], s49 offen lds
s_add_u32 m0, s42, 107520
s_add_u32 s49, s43, 176128
buffer_load_dwordx4 v5, s[36:39], s49 offen lds
s_lshl_b32 s49, s56, 11
s_add_u32 s49, s49, 159232
v_lshrrev_b32 v16, 9, v1
v_lshlrev_b32 v16, 6, v16
v_add_u32 v16, s49, v16
s_lshl_b32 s49, s56, 5
v_xor_b32 v3, s49, v2
s_lshl_b32 s49, s56, 11
v_add_u32 v3, s49, v3
v_add_u32 v4, 0x10000, v3
v_add_u32 v17, 0x20000, v3
s_lshl_b32 s49, s46, 12
s_add_u32 s49, s49, 115712
v_add_u32 v18, s49, v1
s_xor_b32 s50, s46, 4
s_lshl_b32 s49, s50, 12
s_add_u32 s49, s49, 115712
v_add_u32 v19, s49, v1
ds_read_b128 v[24:27], v16 offset:0
ds_read_b128 v[28:31], v16 offset:16
ds_read_b128 v[32:35], v16 offset:32
ds_read_b128 v[36:39], v16 offset:48
ds_read_b128 v[40:43], v16 offset:128
ds_read_b128 v[44:47], v16 offset:144
ds_read_b128 v[48:51], v16 offset:160
ds_read_b128 v[52:55], v16 offset:176
ds_read_b64_tr_b16 v[56:57], v4 offset:50176
ds_read_b64_tr_b16 v[58:59], v4 offset:50432
ds_read_b64_tr_b16 v[60:61], v4 offset:51200
ds_read_b64_tr_b16 v[62:63], v4 offset:51456
ds_read_b64_tr_b16 v[64:65], v4 offset:54272
ds_read_b64_tr_b16 v[66:67], v4 offset:54528
ds_read_b64_tr_b16 v[68:69], v4 offset:55296
ds_read_b64_tr_b16 v[70:71], v4 offset:55552
s_cmp_lg_u32 s46, 0
s_cbranch_scc1 Lg24
v_lshrrev_b32 v7, 2, v1
v_and_b32 v7, 60, v7
s_lshl_b32 s50, s44, 5
s_lshl_b32 s50, s50, 2
s_add_u32 s50, s50, 49152
s_mov_b32 s52, 400000
Lp25:
buffer_load_dword v22, v7, s[32:35], s50 offen sc1
s_waitcnt vmcnt(0)
v_cmp_ne_u32 vcc, s47, v22
s_nop 0
s_cbranch_vccz Ld26
s_sub_u32 s52, s52, 1
s_cmp_lg_u32 s52, 0
s_cbranch_scc1 Lp25
Ld26:
Lg24:
s_waitcnt vmcnt(0)
s_waitcnt lgkmcnt(0)
s_barrier
s_lshl_b32 s58, s48, 11
s_add_u32 s58, s58, 65536
v_and_b32 v6, 0x1f0, v1
v_and_b32 v7, 0x200, v1
v_lshl_add_u32 v6, v7, 1, v6
buffer_load_dwordx4 v[160:163], v6, s[32:35], s58 offen offset:0 sc1
buffer_load_dwordx4 v[164:167], v6, s[32:35], s58 offen offset:512 sc1
s_lshl_b32 s58, s48, 15
s_lshl_b32 s51, s56, 14
s_add_u32 s58, s58, s51
s_add_u32 s58, s58, 7340032
buffer_load_dwordx4 v[192:195], v1, s[32:35], s58 offen offset:0 sc1
buffer_load_dwordx4 v[196:199], v1, s[32:35], s58 offen offset:1024 sc1
buffer_load_dwordx4 v[200:203], v1, s[32:35], s58 offen offset:2048 sc1
buffer_load_dwordx4 v[204:207], v1, s[32:35], s58 offen offset:3072 sc1
s_add_u32 s58, s58, 4096
buffer_load_dwordx4 v[208:211], v1, s[32:35], s58 offen offset:0 sc1
buffer_load_dwordx4 v[212:215], v1, s[32:35], s58 offen offset:1024 sc1
s_waitcnt vmcnt(6)
v_add_f32 v160, v160, v162
v_add_f32 v161, v161, v163
v_add_f32 v160, v160, v164
v_add_f32 v161, v161, v165
v_add_f32 v160, v160, v166
v_add_f32 v161, v161, v167
v_mov_b32 v162, v160
s_nop 1
v_permlane32_swap_b32 v160, v162
v_add_f32 v160, v160, v162
v_mov_b32 v162, v161
s_nop 1
v_permlane32_swap_b32 v161, v162
v_add_f32 v161, v161, v162
v_mul_f32 v160, 0x3b000000, v160
v_mul_f32 v161, 0x3b000000, v161
v_fma_f32 v161, -v160, v160, v161
v_max_f32 v161, 0, v161
v_add_f32 v161, 0x3727c5ac, v161
v_rsq_f32 v92, v161
s_nop 0
v_mul_f32 v93, v160, v92
v_sub_f32 v93, 0, v93
s_waitcnt vmcnt(5)
v_lshlrev_b32 v88, 16, v192
v_and_b32 v89, s54, v192
v_fma_f32 v88, v88, v92, v93
v_fma_f32 v89, v89, v92, v93
v_fmac_f32 v32, v88, v24
v_fmac_f32 v33, v89, v25
v_cvt_pk_bf16_f32 v192, v32, v33
v_lshlrev_b32 v90, 16, v193
v_and_b32 v91, s54, v193
v_fma_f32 v90, v90, v92, v93
v_fma_f32 v91, v91, v92, v93
v_fmac_f32 v34, v90, v26
v_fmac_f32 v35, v91, v27
v_cvt_pk_bf16_f32 v193, v34, v35
v_lshlrev_b32 v88, 16, v194
v_and_b32 v89, s54, v194
v_fma_f32 v88, v88, v92, v93
v_fma_f32 v89, v89, v92, v93
v_fmac_f32 v36, v88, v28
v_fmac_f32 v37, v89, v29
v_cvt_pk_bf16_f32 v194, v36, v37
v_lshlrev_b32 v90, 16, v195
v_and_b32 v91, s54, v195
v_fma_f32 v90, v90, v92, v93
v_fma_f32 v91, v91, v92, v93
v_fmac_f32 v38, v90, v30
v_fmac_f32 v39, v91, v31
v_cvt_pk_bf16_f32 v195, v38, v39
s_mul_i32 s59, s48, 88064
s_lshl_b32 s51, s40, 11
s_add_u32 s59, s59, s51
s_lshl_b32 s51, s56, 10
s_add_u32 s59, s59, s51
s_add_u32 s59, s59, 9437184
s_waitcnt lgkmcnt(0)
v_mfma_f32_32x32x16_bf16 v[96:111], v[56:59], v[192:195], 0
ds_read_b64_tr_b16 v[72:73], v4 offset:58368
ds_read_b64_tr_b16 v[74:75], v4 offset:58624
ds_read_b64_tr_b16 v[76:77], v4 offset:59392
ds_read_b64_tr_b16 v[78:79], v4 offset:59648
ds_read_b128 v[24:27], v16 offset:256
ds_read_b128 v[28:31], v16 offset:272
ds_read_b128 v[32:35], v16 offset:288
ds_read_b128 v[36:39], v16 offset:304
buffer_load_dwordx4 v[216:219], v1, s[32:35], s58 offen offset:2048 sc1
s_waitcnt vmcnt(5)
v_lshlrev_b32 v88, 16, v196
v_and_b32 v89, s54, v196
v_fma_f32 v88, v88, v92, v93
v_fma_f32 v89, v89, v92, v93
v_fmac_f32 v48, v88, v40
v_fmac_f32 v49, v89, v41
v_cvt_pk_bf16_f32 v196, v48, v49
v_lshlrev_b32 v90, 16, v197
v_and_b32 v91, s54, v197
v_fma_f32 v90, v90, v92, v93
v_mfma_f32_32x32x16_bf16 v[112:127], v[60:63], v[192:195], 0
v_fma_f32 v91, v91, v92, v93
v_fmac_f32 v50, v90, v42
v_fmac_f32 v51, v91, v43
v_cvt_pk_bf16_f32 v197, v50, v51
v_lshlrev_b32 v88, 16, v198
v_and_b32 v89, s54, v198
v_fma_f32 v88, v88, v92, v93
v_fma_f32 v89, v89, v92, v93
v_fmac_f32 v52, v88, v44
v_fmac_f32 v53, v89, v45
v_cvt_pk_bf16_f32 v198, v52, v53
v_lshlrev_b32 v90, 16, v199
v_and_b32 v91, s54, v199
v_fma_f32 v90, v90, v92, v93
v_fma_f32 v91, v91, v92, v93
v_fmac_f32 v54, v90, v46
v_fmac_f32 v55, v91, v47
v_cvt_pk_bf16_f32 v199, v54, v55
s_waitcnt lgkmcnt(0)
s_nop 0
v_mfma_f32_32x32x16_bf16 v[96:111], v[64:67], v[196:199], v[96:111]
ds_read_b64_tr_b16 v[56:57], v4 offset:62464
ds_read_b64_tr_b16 v[58:59], v4 offset:62720
ds_read_b64_tr_b16 v[60:61], v4 offset:63488
ds_read_b64_tr_b16 v[62:63], v4 offset:63744
ds_read_b128 v[40:43], v16 offset:384
ds_read_b128 v[44:47], v16 offset:400
ds_read_b128 v[48:51], v16 offset:416
ds_read_b128 v[52:55], v16 offset:432
buffer_load_dwordx4 v[220:223], v1, s[32:35], s58 offen offset:3072 sc1
s_waitcnt vmcnt(5)
v_lshlrev_b32 v88, 16, v200
v_and_b32 v89, s54, v200
v_fma_f32 v88, v88, v92, v93
v_fma_f32 v89, v89, v92, v93
v_fmac_f32 v32, v88, v24
v_fmac_f32 v33, v89, v25
v_cvt_pk_bf16_f32 v200, v32, v33
v_lshlrev_b32 v90, 16, v201
v_and_b32 v91, s54, v201
v_fma_f32 v90, v90, v92, v93
v_mfma_f32_32x32x16_bf16 v[112:127], v[68:71], v[196:199], v[112:127]
v_fma_f32 v91, v91, v92, v93
v_fmac_f32 v34, v90, v26
v_fmac_f32 v35, v91, v27
v_cvt_pk_bf16_f32 v201, v34, v35
v_lshlrev_b32 v88, 16, v202
v_and_b32 v89, s54, v202
v_fma_f32 v88, v88, v92, v93
v_fma_f32 v89, v89, v92, v93
v_fmac_f32 v36, v88, v28
v_fmac_f32 v37, v89, v29
v_cvt_pk_bf16_f32 v202, v36, v37
v_lshlrev_b32 v90, 16, v203
v_and_b32 v91, s54, v203
v_fma_f32 v90, v90, v92, v93
v_fma_f32 v91, v91, v92, v93
v_fmac_f32 v38, v90, v30
v_fmac_f32 v39, v91, v31
v_cvt_pk_bf16_f32 v203, v38, v39
s_waitcnt lgkmcnt(0)
s_nop 0
v_mfma_f32_32x32x16_bf16 v[96:111], v[72:75], v[200:203], v[96:111]
ds_read_b64_tr_b16 v[64:65], v17 offset:1024
ds_read_b64_tr_b16 v[66:67], v17 offset:1280
ds_read_b64_tr_b16 v[68:69], v17 offset:2048
ds_read_b64_tr_b16 v[70:71], v17 offset:2304
ds_read_b128 v[24:27], v16 offset:512
ds_read_b128 v[28:31], v16 offset:528
ds_read_b128 v[32:35], v16 offset:544
ds_read_b128 v[36:39], v16 offset:560
s_add_u32 s58, s58, 4096
buffer_load_dwordx4 v[224:227], v1, s[32:35], s58 offen offset:0 sc1
s_waitcnt vmcnt(5)
v_lshlrev_b32 v88, 16, v204
v_and_b32 v89, s54, v204
v_fma_f32 v88, v88, v92, v93
v_fma_f32 v89, v89, v92, v93
v_fmac_f32 v48, v88, v40
v_fmac_f32 v49, v89, v41
v_cvt_pk_bf16_f32 v204, v48, v49
v_lshlrev_b32 v90, 16, v205
v_and_b32 v91, s54, v205
v_fma_f32 v90, v90, v92, v93
v_mfma_f32_32x32x16_bf16 v[112:127], v[76:79], v[200:203], v[112:127]
v_fma_f32 v91, v91, v92, v93
v_fmac_f32 v50, v90, v42
v_fmac_f32 v51, v91, v43
v_cvt_pk_bf16_f32 v205, v50, v51
v_lshlrev_b32 v88, 16, v206
v_and_b32 v89, s54, v206
v_fma_f32 v88, v88, v92, v93
v_fma_f32 v89, v89, v92, v93
v_fmac_f32 v52, v88, v44
v_fmac_f32 v53, v89, v45
v_cvt_pk_bf16_f32 v206, v52, v53
v_lshlrev_b32 v90, 16, v207
v_and_b32 v91, s54, v207
v_fma_f32 v90, v90, v92, v93
v_fma_f32 v91, v91, v92, v93
v_fmac_f32 v54, v90, v46
v_fmac_f32 v55, v91, v47
v_cvt_pk_bf16_f32 v207, v54, v55
s_waitcnt lgkmcnt(0)
s_nop 0
v_mfma_f32_32x32x16_bf16 v[96:111], v[56:59], v[204:207], v[96:111]
ds_read_b64_tr_b16 v[72:73], v17 offset:5120
ds_read_b64_tr_b16 v[74:75], v17 offset:5376
ds_read_b64_tr_b16 v[76:77], v17 offset:6144
ds_read_b64_tr_b16 v[78:79], v17 offset:6400
ds_read_b128 v[40:43], v16 offset:640
ds_read_b128 v[44:47], v16 offset:656
ds_read_b128 v[48:51], v16 offset:672
ds_read_b128 v[52:55], v16 offset:688
buffer_load_dwordx4 v[228:231], v1, s[32:35], s58 offen offset:1024 sc1
s_waitcnt vmcnt(5)
v_lshlrev_b32 v88, 16, v208
v_and_b32 v89, s54, v208
v_fma_f32 v88, v88, v92, v93
v_fma_f32 v89, v89, v92, v93
v_fmac_f32 v32, v88, v24
v_fmac_f32 v33, v89, v25
v_cvt_pk_bf16_f32 v208, v32, v33
v_lshlrev_b32 v90, 16, v209
v_and_b32 v91, s54, v209
v_fma_f32 v90, v90, v92, v93
v_mfma_f32_32x32x16_bf16 v[112:127], v[60:63], v[204:207], v[112:127]
v_fma_f32 v91, v91, v92, v93
v_fmac_f32 v34, v90, v26
v_fmac_f32 v35, v91, v27
v_cvt_pk_bf16_f32 v209, v34, v35
v_lshlrev_b32 v88, 16, v210
v_and_b32 v89, s54, v210
v_fma_f32 v88, v88, v92, v93
v_fma_f32 v89, v89, v92, v93
v_fmac_f32 v36, v88, v28
v_fmac_f32 v37, v89, v29
v_cvt_pk_bf16_f32 v210, v36, v37
v_lshlrev_b32 v90, 16, v211
v_and_b32 v91, s54, v211
v_fma_f32 v90, v90, v92, v93
v_fma_f32 v91, v91, v92, v93
v_fmac_f32 v38, v90, v30
v_fmac_f32 v39, v91, v31
v_cvt_pk_bf16_f32 v211, v38, v39
s_waitcnt lgkmcnt(0)
s_nop 0
v_mfma_f32_32x32x16_bf16 v[96:111], v[64:67], v[208:211], v[96:111]
ds_read_b64_tr_b16 v[56:57], v17 offset:9216
ds_read_b64_tr_b16 v[58:59], v17 offset:9472
ds_read_b64_tr_b16 v[60:61], v17 offset:10240
ds_read_b64_tr_b16 v[62:63], v17 offset:10496
ds_read_b128 v[24:27], v16 offset:768
ds_read_b128 v[28:31], v16 offset:784
ds_read_b128 v[32:35], v16 offset:800
ds_read_b128 v[36:39], v16 offset:816
buffer_load_dwordx4 v[232:235], v1, s[32:35], s58 offen offset:2048 sc1
s_waitcnt vmcnt(5)
v_lshlrev_b32 v88, 16, v212
v_and_b32 v89, s54, v212
v_fma_f32 v88, v88, v92, v93
v_fma_f32 v89, v89, v92, v93
v_fmac_f32 v48, v88, v40
v_fmac_f32 v49, v89, v41
v_cvt_pk_bf16_f32 v212, v48, v49
v_lshlrev_b32 v90, 16, v213
v_and_b32 v91, s54, v213
v_fma_f32 v90, v90, v92, v93
v_mfma_f32_32x32x16_bf16 v[112:127], v[68:71], v[208:211], v[112:127]
v_fma_f32 v91, v91, v92, v93
v_fmac_f32 v50, v90, v42
v_fmac_f32 v51, v91, v43
v_cvt_pk_bf16_f32 v213, v50, v51
v_lshlrev_b32 v88, 16, v214
v_and_b32 v89, s54, v214
v_fma_f32 v88, v88, v92, v93
v_fma_f32 v89, v89, v92, v93
v_fmac_f32 v52, v88, v44
v_fmac_f32 v53, v89, v45
v_cvt_pk_bf16_f32 v214, v52, v53
v_lshlrev_b32 v90, 16, v215
v_and_b32 v91, s54, v215
v_fma_f32 v90, v90, v92, v93
v_fma_f32 v91, v91, v92, v93
v_fmac_f32 v54, v90, v46
v_fmac_f32 v55, v91, v47
v_cvt_pk_bf16_f32 v215, v54, v55
s_waitcnt lgkmcnt(0)
s_nop 0
v_mfma_f32_32x32x16_bf16 v[96:111], v[72:75], v[212:215], v[96:111]
ds_read_b64_tr_b16 v[64:65], v17 offset:13312
ds_read_b64_tr_b16 v[66:67], v17 offset:13568
ds_read_b64_tr_b16 v[68:69], v17 offset:14336
ds_read_b64_tr_b16 v[70:71], v17 offset:14592
ds_read_b128 v[40:43], v16 offset:896
ds_read_b128 v[44:47], v16 offset:912
ds_read_b128 v[48:51], v16 offset:928
ds_read_b128 v[52:55], v16 offset:944
buffer_load_dwordx4 v[236:239], v1, s[32:35], s58 offen offset:3072 sc1
s_waitcnt vmcnt(5)
v_lshlrev_b32 v88, 16, v216
v_and_b32 v89, s54, v216
v_fma_f32 v88, v88, v92, v93
v_fma_f32 v89, v89, v92, v93
v_fmac_f32 v32, v88, v24
v_fmac_f32 v33, v89, v25
v_cvt_pk_bf16_f32 v216, v32, v33
v_lshlrev_b32 v90, 16, v217
v_and_b32 v91, s54, v217
v_fma_f32 v90, v90, v92, v93
v_mfma_f32_32x32x16_bf16 v[112:127], v[76:79], v[212:215], v[112:127]
v_fma_f32 v91, v91, v92, v93
v_fmac_f32 v34, v90, v26
v_fmac_f32 v35, v91, v27
v_cvt_pk_bf16_f32 v217, v34, v35
v_lshlrev_b32 v88, 16, v218
v_and_b32 v89, s54, v218
v_fma_f32 v88, v88, v92, v93
v_fma_f32 v89, v89, v92, v93
v_fmac_f32 v36, v88, v28
v_fmac_f32 v37, v89, v29
v_cvt_pk_bf16_f32 v218, v36, v37
v_lshlrev_b32 v90, 16, v219
v_and_b32 v91, s54, v219
v_fma_f32 v90, v90, v92, v93
v_fma_f32 v91, v91, v92, v93
v_fmac_f32 v38, v90, v30
v_fmac_f32 v39, v91, v31
v_cvt_pk_bf16_f32 v219, v38, v39
s_waitcnt lgkmcnt(0)
s_nop 0
v_mfma_f32_32x32x16_bf16 v[96:111], v[56:59], v[216:219], v[96:111]
ds_read_b64_tr_b16 v[72:73], v17 offset:17408
ds_read_b64_tr_b16 v[74:75], v17 offset:17664
ds_read_b64_tr_b16 v[76:77], v17 offset:18432
ds_read_b64_tr_b16 v[78:79], v17 offset:18688
ds_read_b128 v[24:27], v16 offset:1024
ds_read_b128 v[28:31], v16 offset:1040
ds_read_b128 v[32:35], v16 offset:1056
ds_read_b128 v[36:39], v16 offset:1072
s_add_u32 s58, s58, 4096
buffer_load_dwordx4 v[240:243], v1, s[32:35], s58 offen offset:0 sc1
s_waitcnt vmcnt(5)
v_lshlrev_b32 v88, 16, v220
v_and_b32 v89, s54, v220
v_fma_f32 v88, v88, v92, v93
v_fma_f32 v89, v89, v92, v93
v_fmac_f32 v48, v88, v40
v_fmac_f32 v49, v89, v41
v_cvt_pk_bf16_f32 v220, v48, v49
v_lshlrev_b32 v90, 16, v221
v_and_b32 v91, s54, v221
v_fma_f32 v90, v90, v92, v93
v_mfma_f32_32x32x16_bf16 v[112:127], v[60:63], v[216:219], v[112:127]
v_fma_f32 v91, v91, v92, v93
v_fmac_f32 v50, v90, v42
v_fmac_f32 v51, v91, v43
v_cvt_pk_bf16_f32 v221, v50, v51
v_lshlrev_b32 v88, 16, v222
v_and_b32 v89, s54, v222
v_fma_f32 v88, v88, v92, v93
v_fma_f32 v89, v89, v92, v93
v_fmac_f32 v52, v88, v44
v_fmac_f32 v53, v89, v45
v_cvt_pk_bf16_f32 v222, v52, v53
v_lshlrev_b32 v90, 16, v223
v_and_b32 v91, s54, v223
v_fma_f32 v90, v90, v92, v93
v_fma_f32 v91, v91, v92, v93
v_fmac_f32 v54, v90, v46
v_fmac_f32 v55, v91, v47
v_cvt_pk_bf16_f32 v223, v54, v55
s_waitcnt lgkmcnt(0)
s_nop 0
v_mfma_f32_32x32x16_bf16 v[96:111], v[64:67], v[220:223], v[96:111]
ds_read_b64_tr_b16 v[56:57], v17 offset:21504
ds_read_b64_tr_b16 v[58:59], v17 offset:21760
ds_read_b64_tr_b16 v[60:61], v17 offset:22528
ds_read_b64_tr_b16 v[62:63], v17 offset:22784
ds_read_b128 v[40:43], v16 offset:1152
ds_read_b128 v[44:47], v16 offset:1168
ds_read_b128 v[48:51], v16 offset:1184
ds_read_b128 v[52:55], v16 offset:1200
buffer_load_dwordx4 v[244:247], v1, s[32:35], s58 offen offset:1024 sc1
s_waitcnt vmcnt(5)
v_lshlrev_b32 v88, 16, v224
v_and_b32 v89, s54, v224
v_fma_f32 v88, v88, v92, v93
v_fma_f32 v89, v89, v92, v93
v_fmac_f32 v32, v88, v24
v_fmac_f32 v33, v89, v25
v_cvt_pk_bf16_f32 v224, v32, v33
v_lshlrev_b32 v90, 16, v225
v_and_b32 v91, s54, v225
v_fma_f32 v90, v90, v92, v93
v_mfma_f32_32x32x16_bf16 v[112:127], v[68:71], v[220:223], v[112:127]
v_fma_f32 v91, v91, v92, v93
v_fmac_f32 v34, v90, v26
v_fmac_f32 v35, v91, v27
v_cvt_pk_bf16_f32 v225, v34, v35
v_lshlrev_b32 v88, 16, v226
v_and_b32 v89, s54, v226
v_fma_f32 v88, v88, v92, v93
v_fma_f32 v89, v89, v92, v93
v_fmac_f32 v36, v88, v28
v_fmac_f32 v37, v89, v29
v_cvt_pk_bf16_f32 v226, v36, v37
v_lshlrev_b32 v90, 16, v227
v_and_b32 v91, s54, v227
v_fma_f32 v90, v90, v92, v93
v_fma_f32 v91, v91, v92, v93
v_fmac_f32 v38, v90, v30
v_fmac_f32 v39, v91, v31
v_cvt_pk_bf16_f32 v227, v38, v39
s_waitcnt lgkmcnt(0)
s_nop 0
v_mfma_f32_32x32x16_bf16 v[96:111], v[72:75], v[224:227], v[96:111]
ds_read_b64_tr_b16 v[64:65], v3 offset:0
ds_read_b64_tr_b16 v[66:67], v3 offset:256
ds_read_b64_tr_b16 v[68:69], v3 offset:1024
ds_read_b64_tr_b16 v[70:71], v3 offset:1280
ds_read_b128 v[24:27], v16 offset:1280
ds_read_b128 v[28:31], v16 offset:1296
ds_read_b128 v[32:35], v16 offset:1312
ds_read_b128 v[36:39], v16 offset:1328
buffer_load_dwordx4 v[248:251], v1, s[32:35], s58 offen offset:2048 sc1
s_waitcnt vmcnt(5)
v_lshlrev_b32 v88, 16, v228
v_and_b32 v89, s54, v228
v_fma_f32 v88, v88, v92, v93
v_fma_f32 v89, v89, v92, v93
v_fmac_f32 v48, v88, v40
v_fmac_f32 v49, v89, v41
v_cvt_pk_bf16_f32 v228, v48, v49
v_lshlrev_b32 v90, 16, v229
v_and_b32 v91, s54, v229
v_fma_f32 v90, v90, v92, v93
v_mfma_f32_32x32x16_bf16 v[112:127], v[76:79], v[224:227], v[112:127]
v_fma_f32 v91, v91, v92, v93
v_fmac_f32 v50, v90, v42
v_fmac_f32 v51, v91, v43
v_cvt_pk_bf16_f32 v229, v50, v51
v_lshlrev_b32 v88, 16, v230
v_and_b32 v89, s54, v230
v_fma_f32 v88, v88, v92, v93
v_fma_f32 v89, v89, v92, v93
v_fmac_f32 v52, v88, v44
v_fmac_f32 v53, v89, v45
v_cvt_pk_bf16_f32 v230, v52, v53
v_lshlrev_b32 v90, 16, v231
v_and_b32 v91, s54, v231
v_fma_f32 v90, v90, v92, v93
v_fma_f32 v91, v91, v92, v93
v_fmac_f32 v54, v90, v46
v_fmac_f32 v55, v91, v47
v_cvt_pk_bf16_f32 v231, v54, v55
s_waitcnt lgkmcnt(0)
s_nop 0
v_mfma_f32_32x32x16_bf16 v[96:111], v[56:59], v[228:231], v[96:111]
ds_read_b64_tr_b16 v[72:73], v3 offset:4096
ds_read_b64_tr_b16 v[74:75], v3 offset:4352
ds_read_b64_tr_b16 v[76:77], v3 offset:5120
ds_read_b64_tr_b16 v[78:79], v3 offset:5376
ds_read_b128 v[40:43], v16 offset:1408
ds_read_b128 v[44:47], v16 offset:1424
ds_read_b128 v[48:51], v16 offset:1440
ds_read_b128 v[52:55], v16 offset:1456
buffer_load_dwordx4 v[252:255], v1, s[32:35], s58 offen offset:3072 sc1
s_waitcnt vmcnt(5)
v_lshlrev_b32 v88, 16, v232
v_and_b32 v89, s54, v232
v_fma_f32 v88, v88, v92, v93
v_fma_f32 v89, v89, v92, v93
v_fmac_f32 v32, v88, v24
v_fmac_f32 v33, v89, v25
v_cvt_pk_bf16_f32 v232, v32, v33
v_lshlrev_b32 v90, 16, v233
v_and_b32 v91, s54, v233
v_fma_f32 v90, v90, v92, v93
v_mfma_f32_32x32x16_bf16 v[112:127], v[60:63], v[228:231], v[112:127]
v_fma_f32 v91, v91, v92, v93
v_fmac_f32 v34, v90, v26
v_fmac_f32 v35, v91, v27
v_cvt_pk_bf16_f32 v233, v34, v35
v_lshlrev_b32 v88, 16, v234
v_and_b32 v89, s54, v234
v_fma_f32 v88, v88, v92, v93
v_fma_f32 v89, v89, v92, v93
v_fmac_f32 v36, v88, v28
v_fmac_f32 v37, v89, v29
v_cvt_pk_bf16_f32 v234, v36, v37
v_lshlrev_b32 v90, 16, v235
v_and_b32 v91, s54, v235
v_fma_f32 v90, v90, v92, v93
v_fma_f32 v91, v91, v92, v93
v_fmac_f32 v38, v90, v30
v_fmac_f32 v39, v91, v31
v_cvt_pk_bf16_f32 v235, v38, v39
s_waitcnt lgkmcnt(0)
s_nop 0
v_mfma_f32_32x32x16_bf16 v[96:111], v[64:67], v[232:235], v[96:111]
ds_read_b64_tr_b16 v[56:57], v3 offset:8192
ds_read_b64_tr_b16 v[58:59], v3 offset:8448
ds_read_b64_tr_b16 v[60:61], v3 offset:9216
ds_read_b64_tr_b16 v[62:63], v3 offset:9472
ds_read_b128 v[24:27], v16 offset:1536
ds_read_b128 v[28:31], v16 offset:1552
ds_read_b128 v[32:35], v16 offset:1568
ds_read_b128 v[36:39], v16 offset:1584
s_waitcnt vmcnt(4)
v_lshlrev_b32 v88, 16, v236
v_and_b32 v89, s54, v236
v_fma_f32 v88, v88, v92, v93
v_fma_f32 v89, v89, v92, v93
v_fmac_f32 v48, v88, v40
v_fmac_f32 v49, v89, v41
v_cvt_pk_bf16_f32 v236, v48, v49
v_lshlrev_b32 v90, 16, v237
v_and_b32 v91, s54, v237
v_fma_f32 v90, v90, v92, v93
v_fma_f32 v91, v91, v92, v93
v_mfma_f32_32x32x16_bf16 v[112:127], v[68:71], v[232:235], v[112:127]
v_fmac_f32 v50, v90, v42
v_fmac_f32 v51, v91, v43
v_cvt_pk_bf16_f32 v237, v50, v51
v_lshlrev_b32 v88, 16, v238
v_and_b32 v89, s54, v238
v_fma_f32 v88, v88, v92, v93
v_fma_f32 v89, v89, v92, v93
v_fmac_f32 v52, v88, v44
v_fmac_f32 v53, v89, v45
v_cvt_pk_bf16_f32 v238, v52, v53
v_lshlrev_b32 v90, 16, v239
v_and_b32 v91, s54, v239
v_fma_f32 v90, v90, v92, v93
v_fma_f32 v91, v91, v92, v93
v_fmac_f32 v54, v90, v46
v_fmac_f32 v55, v91, v47
v_cvt_pk_bf16_f32 v239, v54, v55
v_min_u32 v6, 0x2a0, v1
v_lshlrev_b32 v6, 3, v6
s_mul_i32 s49, s60, 44032
s_mul_i32 s51, s46, 5504
s_add_u32 s49, s49, s51
buffer_load_dword v23, v6, s[24:27], s49 offen
s_waitcnt lgkmcnt(0)
v_mfma_f32_32x32x16_bf16 v[96:111], v[72:75], v[236:239], v[96:111]
ds_read_b64_tr_b16 v[64:65], v3 offset:12288
ds_read_b64_tr_b16 v[66:67], v3 offset:12544
ds_read_b64_tr_b16 v[68:69], v3 offset:13312
ds_read_b64_tr_b16 v[70:71], v3 offset:13568
ds_read_b128 v[40:43], v16 offset:1664
ds_read_b128 v[44:47], v16 offset:1680
ds_read_b128 v[48:51], v16 offset:1696
ds_read_b128 v[52:55], v16 offset:1712
s_waitcnt vmcnt(4)
v_lshlrev_b32 v88, 16, v240
v_and_b32 v89, s54, v240
v_fma_f32 v88, v88, v92, v93
v_fma_f32 v89, v89, v92, v93
v_fmac_f32 v32, v88, v24
v_fmac_f32 v33, v89, v25
v_cvt_pk_bf16_f32 v240, v32, v33
v_lshlrev_b32 v90, 16, v241
v_and_b32 v91, s54, v241
v_fma_f32 v90, v90, v92, v93
v_mfma_f32_32x32x16_bf16 v[112:127], v[76:79], v[236:239], v[112:127]
v_fma_f32 v91, v91, v92, v93
v_fmac_f32 v34, v90, v26
v_fmac_f32 v35, v91, v27
v_cvt_pk_bf16_f32 v241, v34, v35
v_lshlrev_b32 v88, 16, v242
v_and_b32 v89, s54, v242
v_fma_f32 v88, v88, v92, v93
v_fma_f32 v89, v89, v92, v93
v_fmac_f32 v36, v88, v28
v_fmac_f32 v37, v89, v29
v_cvt_pk_bf16_f32 v242, v36, v37
v_lshlrev_b32 v90, 16, v243
v_and_b32 v91, s54, v243
v_fma_f32 v90, v90, v92, v93
v_fma_f32 v91, v91, v92, v93
v_fmac_f32 v38, v90, v30
v_fmac_f32 v39, v91, v31
v_cvt_pk_bf16_f32 v243, v38, v39
s_waitcnt lgkmcnt(0)
s_nop 0
v_mfma_f32_32x32x16_bf16 v[96:111], v[56:59], v[240:243], v[96:111]
ds_read_b64_tr_b16 v[72:73], v3 offset:16384
ds_read_b64_tr_b16 v[74:75], v3 offset:16640
ds_read_b64_tr_b16 v[76:77], v3 offset:17408
ds_read_b64_tr_b16 v[78:79], v3 offset:17664
ds_read_b128 v[24:27], v16 offset:1792
ds_read_b128 v[28:31], v16 offset:1808
ds_read_b128 v[32:35], v16 offset:1824
ds_read_b128 v[36:39], v16 offset:1840
s_waitcnt vmcnt(3)
v_lshlrev_b32 v88, 16, v244
v_and_b32 v89, s54, v244
v_fma_f32 v88, v88, v92, v93
v_fma_f32 v89, v89, v92, v93
v_fmac_f32 v48, v88, v40
v_fmac_f32 v49, v89, v41
v_cvt_pk_bf16_f32 v244, v48, v49
v_lshlrev_b32 v90, 16, v245
v_and_b32 v91, s54, v245
v_fma_f32 v90, v90, v92, v93
v_mfma_f32_32x32x16_bf16 v[112:127], v[60:63], v[240:243], v[112:127]
v_fma_f32 v91, v91, v92, v93
v_fmac_f32 v50, v90, v42
v_fmac_f32 v51, v91, v43
v_cvt_pk_bf16_f32 v245, v50, v51
v_lshlrev_b32 v88, 16, v246
v_and_b32 v89, s54, v246
v_fma_f32 v88, v88, v92, v93
v_fma_f32 v89, v89, v92, v93
v_fmac_f32 v52, v88, v44
v_fmac_f32 v53, v89, v45
v_cvt_pk_bf16_f32 v246, v52, v53
v_lshlrev_b32 v90, 16, v247
v_and_b32 v91, s54, v247
v_fma_f32 v90, v90, v92, v93
v_fma_f32 v91, v91, v92, v93
v_fmac_f32 v54, v90, v46
v_fmac_f32 v55, v91, v47
v_cvt_pk_bf16_f32 v247, v54, v55
s_waitcnt lgkmcnt(0)
s_nop 0
v_mfma_f32_32x32x16_bf16 v[96:111], v[64:67], v[244:247], v[96:111]
ds_read_b64_tr_b16 v[56:57], v3 offset:20480
ds_read_b64_tr_b16 v[58:59], v3 offset:20736
ds_read_b64_tr_b16 v[60:61], v3 offset:21504
ds_read_b64_tr_b16 v[62:63], v3 offset:21760
ds_read_b128 v[40:43], v16 offset:1920
ds_read_b128 v[44:47], v16 offset:1936
ds_read_b128 v[48:51], v16 offset:1952
ds_read_b128 v[52:55], v16 offset:1968
s_waitcnt vmcnt(2)
v_lshlrev_b32 v88, 16, v248
v_and_b32 v89, s54, v248
v_fma_f32 v88, v88, v92, v93
v_fma_f32 v89, v89, v92, v93
v_fmac_f32 v32, v88, v24
v_fmac_f32 v33, v89, v25
v_cvt_pk_bf16_f32 v248, v32, v33
v_lshlrev_b32 v90, 16, v249
v_and_b32 v91, s54, v249
v_fma_f32 v90, v90, v92, v93
v_mfma_f32_32x32x16_bf16 v[112:127], v[68:71], v[244:247], v[112:127]
v_fma_f32 v91, v91, v92, v93
v_fmac_f32 v34, v90, v26
v_fmac_f32 v35, v91, v27
v_cvt_pk_bf16_f32 v249, v34, v35
v_lshlrev_b32 v88, 16, v250
v_and_b32 v89, s54, v250
v_fma_f32 v88, v88, v92, v93
v_fma_f32 v89, v89, v92, v93
v_fmac_f32 v36, v88, v28
v_fmac_f32 v37, v89, v29
v_cvt_pk_bf16_f32 v250, v36, v37
v_lshlrev_b32 v90, 16, v251
v_and_b32 v91, s54, v251
v_fma_f32 v90, v90, v92, v93
v_fma_f32 v91, v91, v92, v93
v_fmac_f32 v38, v90, v30
v_fmac_f32 v39, v91, v31
v_cvt_pk_bf16_f32 v251, v38, v39
s_waitcnt lgkmcnt(0)
s_nop 0
v_mfma_f32_32x32x16_bf16 v[96:111], v[72:75], v[248:251], v[96:111]
ds_read_b64_tr_b16 v[64:65], v3 offset:24576
ds_read_b64_tr_b16 v[66:67], v3 offset:24832
ds_read_b64_tr_b16 v[68:69], v3 offset:25600
ds_read_b64_tr_b16 v[70:71], v3 offset:25856
s_waitcnt vmcnt(1)
v_lshlrev_b32 v88, 16, v252
v_and_b32 v89, s54, v252
v_fma_f32 v88, v88, v92, v93
v_fma_f32 v89, v89, v92, v93
v_fmac_f32 v48, v88, v40
v_fmac_f32 v49, v89, v41
v_cvt_pk_bf16_f32 v252, v48, v49
v_lshlrev_b32 v90, 16, v253
v_and_b32 v91, s54, v253
v_fma_f32 v90, v90, v92, v93
v_fma_f32 v91, v91, v92, v93
v_fmac_f32 v50, v90, v42
v_mfma_f32_32x32x16_bf16 v[112:127], v[76:79], v[248:251], v[112:127]
v_fmac_f32 v51, v91, v43
v_cvt_pk_bf16_f32 v253, v50, v51
v_lshlrev_b32 v88, 16, v254
v_and_b32 v89, s54, v254
v_fma_f32 v88, v88, v92, v93
v_fma_f32 v89, v89, v92, v93
v_fmac_f32 v52, v88, v44
v_fmac_f32 v53, v89, v45
v_cvt_pk_bf16_f32 v254, v52, v53
v_lshlrev_b32 v90, 16, v255
v_and_b32 v91, s54, v255
v_fma_f32 v90, v90, v92, v93
v_fma_f32 v91, v91, v92, v93
v_fmac_f32 v54, v90, v46
v_fmac_f32 v55, v91, v47
v_cvt_pk_bf16_f32 v255, v54, v55
s_waitcnt lgkmcnt(0)
s_waitcnt lgkmcnt(0)
s_barrier
v_mfma_f32_32x32x16_bf16 v[96:111], v[56:59], v[252:255], v[96:111]
ds_read_b64_tr_b16 v[72:73], v3 offset:28672
ds_read_b64_tr_b16 v[74:75], v3 offset:28928
ds_read_b64_tr_b16 v[76:77], v3 offset:29696
ds_read_b64_tr_b16 v[78:79], v3 offset:29952
v_mfma_f32_32x32x16_bf16 v[112:127], v[60:63], v[252:255], v[112:127]
s_add_u32 m0, s42, 0
s_add_u32 s49, s43, 264192
buffer_load_dwordx4 v5, s[36:39], s49 offen lds
v_mfma_f32_32x32x16_bf16 v[128:143], v[64:67], v[192:195], 0
ds_read_b64_tr_b16 v[56:57], v3 offset:32768
ds_read_b64_tr_b16 v[58:59], v3 offset:33024
ds_read_b64_tr_b16 v[60:61], v3 offset:33792
ds_read_b64_tr_b16 v[62:63], v3 offset:34048
v_mfma_f32_32x32x16_bf16 v[144:159], v[68:71], v[192:195], 0
s_add_u32 m0, s42, 8192
s_add_u32 s49, s43, 352256
buffer_load_dwordx4 v5, s[36:39], s49 offen lds
s_waitcnt lgkmcnt(4)
v_mfma_f32_32x32x16_bf16 v[128:143], v[72:75], v[196:199], v[128:143]
ds_read_b64_tr_b16 v[64:65], v3 offset:36864
ds_read_b64_tr_b16 v[66:67], v3 offset:37120
ds_read_b64_tr_b16 v[68:69], v3 offset:37888
ds_read_b64_tr_b16 v[70:71], v3 offset:38144
ds_write_b128 v18, v[104:107] offset:0
ds_write_b128 v18, v[108:111] offset:1024
ds_write_b128 v18, v[120:123] offset:2048
v_mfma_f32_32x32x16_bf16 v[144:159], v[76:79], v[196:199], v[144:159]
ds_write_b128 v18, v[124:127] offset:3072
s_waitcnt lgkmcnt(0)
s_waitcnt vmcnt(2)
s_barrier
ds_read_b128 v[160:163], v19 offset:0
s_add_u32 m0, s42, 16384
s_add_u32 s49, s43, 440320
buffer_load_dwordx4 v5, s[36:39], s49 offen lds
v_mfma_f32_32x32x16_bf16 v[128:143], v[56:59], v[200:203], v[128:143]
ds_read_b64_tr_b16 v[72:73], v3 offset:40960
ds_read_b64_tr_b16 v[74:75], v3 offset:41216
ds_read_b64_tr_b16 v[76:77], v3 offset:41984
ds_read_b64_tr_b16 v[78:79], v3 offset:42240
ds_read_b128 v[164:167], v19 offset:1024
ds_read_b128 v[168:171], v19 offset:2048
ds_read_b128 v[172:175], v19 offset:3072
v_mfma_f32_32x32x16_bf16 v[144:159], v[60:63], v[200:203], v[144:159]
s_waitcnt lgkmcnt(0)
v_add_f32 v176, v96, v160
v_add_f32 v177, v97, v161
s_add_u32 m0, s42, 148480
s_add_u32 s49, s43, 528384
buffer_load_dwordx4 v5, s[36:39], s49 offen lds
v_mfma_f32_32x32x16_bf16 v[128:143], v[64:67], v[204:207], v[128:143]
ds_read_b64_tr_b16 v[56:57], v3 offset:45056
ds_read_b64_tr_b16 v[58:59], v3 offset:45312
ds_read_b64_tr_b16 v[60:61], v3 offset:46080
ds_read_b64_tr_b16 v[62:63], v3 offset:46336
v_add_f32 v178, v112, v168
v_add_f32 v179, v113, v169
v_mfma_f32_32x32x16_bf16 v[144:159], v[68:71], v[204:207], v[144:159]
v_mul_f32 v176, 0xbfb8aa3b, v176
v_mul_f32 v177, 0xbfb8aa3b, v177
v_exp_f32 v176, v176
v_exp_f32 v177, v177
v_mfma_f32_32x32x16_bf16 v[128:143], v[72:75], v[208:211], v[128:143]
ds_read_b64_tr_b16 v[64:65], v3 offset:50176
ds_read_b64_tr_b16 v[66:67], v3 offset:50432
ds_read_b64_tr_b16 v[68:69], v3 offset:51200
ds_read_b64_tr_b16 v[70:71], v3 offset:51456
v_add_f32 v176, 1.0, v176
v_add_f32 v177, 1.0, v177
v_mfma_f32_32x32x16_bf16 v[144:159], v[76:79], v[208:211], v[144:159]
v_rcp_f32 v176, v176
v_rcp_f32 v177, v177
v_mul_f32 v176, v176, v178
v_mul_f32 v177, v177, v179
s_waitcnt lgkmcnt(4)
v_mfma_f32_32x32x16_bf16 v[128:143], v[56:59], v[212:215], v[128:143]
ds_read_b64_tr_b16 v[72:73], v3 offset:54272
ds_read_b64_tr_b16 v[74:75], v3 offset:54528
ds_read_b64_tr_b16 v[76:77], v3 offset:55296
ds_read_b64_tr_b16 v[78:79], v3 offset:55552
v_cvt_pk_bf16_f32 v184, v176, v177
v_add_f32 v180, v98, v162
v_mfma_f32_32x32x16_bf16 v[144:159], v[60:63], v[212:215], v[144:159]
v_add_f32 v181, v99, v163
v_add_f32 v182, v114, v170
v_add_f32 v183, v115, v171
v_mul_f32 v180, 0xbfb8aa3b, v180
s_waitcnt lgkmcnt(4)
v_mfma_f32_32x32x16_bf16 v[128:143], v[64:67], v[216:219], v[128:143]
ds_read_b64_tr_b16 v[56:57], v3 offset:58368
ds_read_b64_tr_b16 v[58:59], v3 offset:58624
ds_read_b64_tr_b16 v[60:61], v3 offset:59392
ds_read_b64_tr_b16 v[62:63], v3 offset:59648
v_mul_f32 v181, 0xbfb8aa3b, v181
v_exp_f32 v180, v180
v_mfma_f32_32x32x16_bf16 v[144:159], v[68:71], v[216:219], v[144:159]
v_exp_f32 v181, v181
v_add_f32 v180, 1.0, v180
v_add_f32 v181, 1.0, v181
v_rcp_f32 v180, v180
s_waitcnt lgkmcnt(4)
v_mfma_f32_32x32x16_bf16 v[128:143], v[72:75], v[220:223], v[128:143]
ds_read_b64_tr_b16 v[64:65], v3 offset:62464
ds_read_b64_tr_b16 v[66:67], v3 offset:62720
ds_read_b64_tr_b16 v[68:69], v3 offset:63488
ds_read_b64_tr_b16 v[70:71], v3 offset:63744
v_rcp_f32 v181, v181
v_mul_f32 v180, v180, v182
v_mfma_f32_32x32x16_bf16 v[144:159], v[76:79], v[220:223], v[144:159]
v_mul_f32 v181, v181, v183
v_cvt_pk_bf16_f32 v185, v180, v181
v_add_f32 v176, v100, v164
v_add_f32 v177, v101, v165
s_waitcnt lgkmcnt(4)
v_mfma_f32_32x32x16_bf16 v[128:143], v[56:59], v[224:227], v[128:143]
ds_read_b64_tr_b16 v[72:73], v4 offset:1024
ds_read_b64_tr_b16 v[74:75], v4 offset:1280
ds_read_b64_tr_b16 v[76:77], v4 offset:2048
ds_read_b64_tr_b16 v[78:79], v4 offset:2304
v_add_f32 v178, v116, v172
v_add_f32 v179, v117, v173
v_mfma_f32_32x32x16_bf16 v[144:159], v[60:63], v[224:227], v[144:159]
v_mul_f32 v176, 0xbfb8aa3b, v176
v_mul_f32 v177, 0xbfb8aa3b, v177
v_exp_f32 v176, v176
v_exp_f32 v177, v177
s_waitcnt lgkmcnt(4)
v_mfma_f32_32x32x16_bf16 v[128:143], v[64:67], v[228:231], v[128:143]
ds_read_b64_tr_b16 v[56:57], v4 offset:5120
ds_read_b64_tr_b16 v[58:59], v4 offset:5376
ds_read_b64_tr_b16 v[60:61], v4 offset:6144
ds_read_b64_tr_b16 v[62:63], v4 offset:6400
v_add_f32 v176, 1.0, v176
v_add_f32 v177, 1.0, v177
v_mfma_f32_32x32x16_bf16 v[144:159], v[68:71], v[228:231], v[144:159]
v_rcp_f32 v176, v176
v_rcp_f32 v177, v177
v_mul_f32 v176, v176, v178
v_mul_f32 v177, v177, v179
s_waitcnt lgkmcnt(4)
v_mfma_f32_32x32x16_bf16 v[128:143], v[72:75], v[232:235], v[128:143]
ds_read_b64_tr_b16 v[64:65], v4 offset:9216
ds_read_b64_tr_b16 v[66:67], v4 offset:9472
ds_read_b64_tr_b16 v[68:69], v4 offset:10240
ds_read_b64_tr_b16 v[70:71], v4 offset:10496
v_cvt_pk_bf16_f32 v186, v176, v177
v_add_f32 v180, v102, v166
v_mfma_f32_32x32x16_bf16 v[144:159], v[76:79], v[232:235], v[144:159]
v_add_f32 v181, v103, v167
v_add_f32 v182, v118, v174
v_add_f32 v183, v119, v175
v_mul_f32 v180, 0xbfb8aa3b, v180
s_waitcnt lgkmcnt(4)
v_mfma_f32_32x32x16_bf16 v[128:143], v[56:59], v[236:239], v[128:143]
ds_read_b64_tr_b16 v[72:73], v4 offset:13312
ds_read_b64_tr_b16 v[74:75], v4 offset:13568
ds_read_b64_tr_b16 v[76:77], v4 offset:14336
ds_read_b64_tr_b16 v[78:79], v4 offset:14592
v_mul_f32 v181, 0xbfb8aa3b, v181
v_exp_f32 v180, v180
v_mfma_f32_32x32x16_bf16 v[144:159], v[60:63], v[236:239], v[144:159]
v_exp_f32 v181, v181
v_add_f32 v180, 1.0, v180
v_add_f32 v181, 1.0, v181
v_rcp_f32 v180, v180
s_waitcnt lgkmcnt(4)
v_mfma_f32_32x32x16_bf16 v[128:143], v[64:67], v[240:243], v[128:143]
ds_read_b64_tr_b16 v[56:57], v4 offset:17408
ds_read_b64_tr_b16 v[58:59], v4 offset:17664
ds_read_b64_tr_b16 v[60:61], v4 offset:18432
ds_read_b64_tr_b16 v[62:63], v4 offset:18688
v_rcp_f32 v181, v181
v_mul_f32 v180, v180, v182
v_mfma_f32_32x32x16_bf16 v[144:159], v[68:71], v[240:243], v[144:159]
v_mul_f32 v181, v181, v183
v_cvt_pk_bf16_f32 v187, v180, v181
buffer_store_dwordx4 v[184:187], v1, s[32:35], s59 offen offset:0 sc1
s_waitcnt lgkmcnt(4)
v_mfma_f32_32x32x16_bf16 v[128:143], v[72:75], v[244:247], v[128:143]
v_mfma_f32_32x32x16_bf16 v[144:159], v[76:79], v[244:247], v[144:159]
ds_read_b64_tr_b16 v[64:65], v4 offset:21504
ds_read_b64_tr_b16 v[66:67], v4 offset:21760
ds_read_b64_tr_b16 v[68:69], v4 offset:22528
ds_read_b64_tr_b16 v[70:71], v4 offset:22784
s_waitcnt lgkmcnt(4)
s_waitcnt vmcnt(1)
s_barrier
v_mfma_f32_32x32x16_bf16 v[128:143], v[56:59], v[248:251], v[128:143]
v_mfma_f32_32x32x16_bf16 v[144:159], v[60:63], v[248:251], v[144:159]
ds_read_b64_tr_b16 v[72:73], v4 offset:25600
ds_read_b64_tr_b16 v[74:75], v4 offset:25856
ds_read_b64_tr_b16 v[76:77], v4 offset:26624
ds_read_b64_tr_b16 v[78:79], v4 offset:26880
s_waitcnt lgkmcnt(4)
s_waitcnt lgkmcnt(0)
s_barrier
v_mfma_f32_32x32x16_bf16 v[128:143], v[64:67], v[252:255], v[128:143]
ds_read_b64_tr_b16 v[56:57], v4 offset:29696
ds_read_b64_tr_b16 v[58:59], v4 offset:29952
ds_read_b64_tr_b16 v[60:61], v4 offset:30720
ds_read_b64_tr_b16 v[62:63], v4 offset:30976
v_mfma_f32_32x32x16_bf16 v[144:159], v[68:71], v[252:255], v[144:159]
s_add_u32 m0, s42, 24576
s_add_u32 s49, s43, 616448
buffer_load_dwordx4 v5, s[36:39], s49 offen lds
v_mfma_f32_32x32x16_bf16 v[96:111], v[72:75], v[192:195], 0
ds_read_b64_tr_b16 v[64:65], v4 offset:33792
ds_read_b64_tr_b16 v[66:67], v4 offset:34048
ds_read_b64_tr_b16 v[68:69], v4 offset:34816
ds_read_b64_tr_b16 v[70:71], v4 offset:35072
v_mfma_f32_32x32x16_bf16 v[112:127], v[76:79], v[192:195], 0
v_lshrrev_b32 v6, 6, v1
v_and_b32 v7, 3, v6
v_bfe_u32 v21, v6, 2, 1
v_lshl_add_u32 v7, v21, 3, v7
v_lshrrev_b32 v6, 3, v6
v_lshl_add_u32 v6, v6, 2, v7
v_lshlrev_b32 v6, 10, v6
v_and_b32 v7, 48, v1
v_add_u32 v21, v6, v7
s_cmp_eq_u32 s1, 3
s_cselect_b32 s50, 1, 0
s_mul_i32 s96, s1, 22
s_sub_u32 s96, s96, s50
s_and_b32 s50, s46, 1
s_lshl_b32 s94, s96, 14
s_lshl_b32 s51, s57, 7
s_add_u32 s94, s94, s51
s_lshl_b32 s51, s50, 6
s_add_u32 s94, s94, s51
s_lshl_b32 s95, s46, 10
s_mov_b32 s93, s96
s_waitcnt lgkmcnt(4)
v_mfma_f32_32x32x16_bf16 v[96:111], v[56:59], v[196:199], v[96:111]
ds_read_b64_tr_b16 v[72:73], v4 offset:37888
ds_read_b64_tr_b16 v[74:75], v4 offset:38144
ds_read_b64_tr_b16 v[76:77], v4 offset:38912
ds_read_b64_tr_b16 v[78:79], v4 offset:39168
ds_write_b128 v18, v[136:139] offset:0
ds_write_b128 v18, v[140:143] offset:1024
ds_write_b128 v18, v[152:155] offset:2048
v_mfma_f32_32x32x16_bf16 v[112:127], v[60:63], v[196:199], v[112:127]
ds_write_b128 v18, v[156:159] offset:3072
s_waitcnt lgkmcnt(0)
s_barrier
ds_read_b128 v[160:163], v19 offset:0
s_add_u32 m0, s95, 32768
s_add_u32 s49, s94, 0
buffer_load_dwordx4 v21, s[24:27], s49 offen lds
v_mfma_f32_32x32x16_bf16 v[96:111], v[64:67], v[200:203], v[96:111]
ds_read_b64_tr_b16 v[56:57], v4 offset:41984
ds_read_b64_tr_b16 v[58:59], v4 offset:42240
ds_read_b64_tr_b16 v[60:61], v4 offset:43008
ds_read_b64_tr_b16 v[62:63], v4 offset:43264
ds_read_b128 v[164:167], v19 offset:1024
ds_read_b128 v[168:171], v19 offset:2048
ds_read_b128 v[172:175], v19 offset:3072
v_mfma_f32_32x32x16_bf16 v[112:127], v[68:71], v[200:203], v[112:127]
s_waitcnt lgkmcnt(0)
v_add_f32 v176, v128, v160
v_add_f32 v177, v129, v161
s_add_u32 m0, s95, 40960
s_add_u32 s49, s94, 16384
buffer_load_dwordx4 v21, s[24:27], s49 offen lds
v_mfma_f32_32x32x16_bf16 v[96:111], v[72:75], v[204:207], v[96:111]
ds_read_b64_tr_b16 v[64:65], v4 offset:46080
ds_read_b64_tr_b16 v[66:67], v4 offset:46336
ds_read_b64_tr_b16 v[68:69], v4 offset:47104
ds_read_b64_tr_b16 v[70:71], v4 offset:47360
v_add_f32 v178, v144, v168
v_add_f32 v179, v145, v169
v_mul_f32 v176, 0xbfb8aa3b, v176
v_mfma_f32_32x32x16_bf16 v[112:127], v[76:79], v[204:207], v[112:127]
v_mul_f32 v177, 0xbfb8aa3b, v177
v_exp_f32 v176, v176
v_exp_f32 v177, v177
s_add_u32 m0, s95, 50176
s_add_u32 s49, s94, 32768
buffer_load_dwordx4 v21, s[24:27], s49 offen lds
v_mfma_f32_32x32x16_bf16 v[96:111], v[56:59], v[208:211], v[96:111]
ds_read_b64_tr_b16 v[72:73], v3 offset:0
ds_read_b64_tr_b16 v[74:75], v3 offset:256
ds_read_b64_tr_b16 v[76:77], v3 offset:1024
ds_read_b64_tr_b16 v[78:79], v3 offset:1280
v_add_f32 v176, 1.0, v176
v_add_f32 v177, 1.0, v177
v_rcp_f32 v176, v176
v_mfma_f32_32x32x16_bf16 v[112:127], v[60:63], v[208:211], v[112:127]
v_rcp_f32 v177, v177
v_mul_f32 v176, v176, v178
v_mul_f32 v177, v177, v179
s_add_u32 m0, s95, 58368
s_add_u32 s49, s94, 49152
buffer_load_dwordx4 v21, s[24:27], s49 offen lds
s_waitcnt lgkmcnt(4)
v_mfma_f32_32x32x16_bf16 v[96:111], v[64:67], v[212:215], v[96:111]
ds_read_b64_tr_b16 v[56:57], v3 offset:4096
ds_read_b64_tr_b16 v[58:59], v3 offset:4352
ds_read_b64_tr_b16 v[60:61], v3 offset:5120
ds_read_b64_tr_b16 v[62:63], v3 offset:5376
v_cvt_pk_bf16_f32 v184, v176, v177
v_add_f32 v180, v130, v162
v_add_f32 v181, v131, v163
v_mfma_f32_32x32x16_bf16 v[112:127], v[68:71], v[212:215], v[112:127]
v_add_f32 v182, v146, v170
v_add_f32 v183, v147, v171
v_mul_f32 v180, 0xbfb8aa3b, v180
s_add_u32 m0, s95, 66560
s_add_u32 s49, s94, 65536
buffer_load_dwordx4 v21, s[24:27], s49 offen lds
s_waitcnt lgkmcnt(4)
v_mfma_f32_32x32x16_bf16 v[96:111], v[72:75], v[216:219], v[96:111]
ds_read_b64_tr_b16 v[64:65], v3 offset:8192
ds_read_b64_tr_b16 v[66:67], v3 offset:8448
ds_read_b64_tr_b16 v[68:69], v3 offset:9216
ds_read_b64_tr_b16 v[70:71], v3 offset:9472
v_mul_f32 v181, 0xbfb8aa3b, v181
v_exp_f32 v180, v180
v_exp_f32 v181, v181
v_mfma_f32_32x32x16_bf16 v[112:127], v[76:79], v[216:219], v[112:127]
v_add_f32 v180, 1.0, v180
v_add_f32 v181, 1.0, v181
v_rcp_f32 v180, v180
s_add_u32 m0, s95, 74752
s_add_u32 s49, s94, 81920
buffer_load_dwordx4 v21, s[24:27], s49 offen lds
s_waitcnt lgkmcnt(4)
v_mfma_f32_32x32x16_bf16 v[96:111], v[56:59], v[220:223], v[96:111]
ds_read_b64_tr_b16 v[72:73], v3 offset:12288
ds_read_b64_tr_b16 v[74:75], v3 offset:12544
ds_read_b64_tr_b16 v[76:77], v3 offset:13312
ds_read_b64_tr_b16 v[78:79], v3 offset:13568
v_rcp_f32 v181, v181
v_mul_f32 v180, v180, v182
v_mul_f32 v181, v181, v183
v_mfma_f32_32x32x16_bf16 v[112:127], v[60:63], v[220:223], v[112:127]
v_cvt_pk_bf16_f32 v185, v180, v181
v_add_f32 v176, v132, v164
v_add_f32 v177, v133, v165
s_add_u32 m0, s95, 82944
s_add_u32 s49, s94, 98304
buffer_load_dwordx4 v21, s[24:27], s49 offen lds
s_waitcnt lgkmcnt(4)
v_mfma_f32_32x32x16_bf16 v[96:111], v[64:67], v[224:227], v[96:111]
ds_read_b64_tr_b16 v[56:57], v3 offset:16384
ds_read_b64_tr_b16 v[58:59], v3 offset:16640
ds_read_b64_tr_b16 v[60:61], v3 offset:17408
ds_read_b64_tr_b16 v[62:63], v3 offset:17664
v_add_f32 v178, v148, v172
v_add_f32 v179, v149, v173
v_mfma_f32_32x32x16_bf16 v[112:127], v[68:71], v[224:227], v[112:127]
v_mul_f32 v176, 0xbfb8aa3b, v176
v_mul_f32 v177, 0xbfb8aa3b, v177
v_exp_f32 v176, v176
v_exp_f32 v177, v177
s_waitcnt lgkmcnt(4)
v_mfma_f32_32x32x16_bf16 v[96:111], v[72:75], v[228:231], v[96:111]
ds_read_b64_tr_b16 v[64:65], v3 offset:20480
ds_read_b64_tr_b16 v[66:67], v3 offset:20736
ds_read_b64_tr_b16 v[68:69], v3 offset:21504
ds_read_b64_tr_b16 v[70:71], v3 offset:21760
v_add_f32 v176, 1.0, v176
v_add_f32 v177, 1.0, v177
v_mfma_f32_32x32x16_bf16 v[112:127], v[76:79], v[228:231], v[112:127]
v_rcp_f32 v176, v176
v_rcp_f32 v177, v177
v_mul_f32 v176, v176, v178
v_mul_f32 v177, v177, v179
s_waitcnt lgkmcnt(4)
v_mfma_f32_32x32x16_bf16 v[96:111], v[56:59], v[232:235], v[96:111]
ds_read_b64_tr_b16 v[72:73], v17 offset:17408
ds_read_b64_tr_b16 v[74:75], v17 offset:17664
ds_read_b64_tr_b16 v[76:77], v17 offset:18432
ds_read_b64_tr_b16 v[78:79], v17 offset:18688
v_cvt_pk_bf16_f32 v186, v176, v177
v_add_f32 v180, v134, v166
v_mfma_f32_32x32x16_bf16 v[112:127], v[60:63], v[232:235], v[112:127]
v_add_f32 v181, v135, v167
v_add_f32 v182, v150, v174
v_add_f32 v183, v151, v175
v_mul_f32 v180, 0xbfb8aa3b, v180
s_waitcnt lgkmcnt(4)
s_waitcnt vmcnt(6)
s_barrier
v_mfma_f32_32x32x16_bf16 v[96:111], v[64:67], v[236:239], v[96:111]
ds_read_b64_tr_b16 v[56:57], v17 offset:21504
ds_read_b64_tr_b16 v[58:59], v17 offset:21760
ds_read_b64_tr_b16 v[60:61], v17 offset:22528
ds_read_b64_tr_b16 v[62:63], v17 offset:22784
v_mul_f32 v181, 0xbfb8aa3b, v181
v_exp_f32 v180, v180
v_mfma_f32_32x32x16_bf16 v[112:127], v[68:71], v[236:239], v[112:127]
v_exp_f32 v181, v181
v_add_f32 v180, 1.0, v180
v_add_f32 v181, 1.0, v181
v_rcp_f32 v180, v180
s_waitcnt lgkmcnt(4)
v_mfma_f32_32x32x16_bf16 v[96:111], v[72:75], v[240:243], v[96:111]
ds_read_b64_tr_b16 v[64:65], v3 offset:24576
ds_read_b64_tr_b16 v[66:67], v3 offset:24832
ds_read_b64_tr_b16 v[68:69], v3 offset:25600
ds_read_b64_tr_b16 v[70:71], v3 offset:25856
v_rcp_f32 v181, v181
v_mul_f32 v180, v180, v182
v_mfma_f32_32x32x16_bf16 v[112:127], v[76:79], v[240:243], v[112:127]
v_mul_f32 v181, v181, v183
v_cvt_pk_bf16_f32 v187, v180, v181
buffer_store_dwordx4 v[184:187], v1, s[32:35], s59 offen offset:2048 sc1
s_add_u32 s59, s59, 4096
s_waitcnt lgkmcnt(4)
v_mfma_f32_32x32x16_bf16 v[96:111], v[56:59], v[244:247], v[96:111]
v_mfma_f32_32x32x16_bf16 v[112:127], v[60:63], v[244:247], v[112:127]
ds_read_b64_tr_b16 v[72:73], v3 offset:28672
ds_read_b64_tr_b16 v[74:75], v3 offset:28928
ds_read_b64_tr_b16 v[76:77], v3 offset:29696
ds_read_b64_tr_b16 v[78:79], v3 offset:29952
s_waitcnt lgkmcnt(4)
v_mfma_f32_32x32x16_bf16 v[96:111], v[64:67], v[248:251], v[96:111]
v_mfma_f32_32x32x16_bf16 v[112:127], v[68:71], v[248:251], v[112:127]
s_waitcnt lgkmcnt(0)
v_mfma_f32_32x32x16_bf16 v[96:111], v[72:75], v[252:255], v[96:111]
v_mfma_f32_32x32x16_bf16 v[112:127], v[76:79], v[252:255], v[112:127]
s_barrier
s_nop 9
ds_write_b128 v18, v[104:107] offset:0
ds_write_b128 v18, v[108:111] offset:1024
ds_write_b128 v18, v[120:123] offset:2048
ds_write_b128 v18, v[124:127] offset:3072
s_waitcnt lgkmcnt(0)
s_barrier
ds_read_b128 v[160:163], v19 offset:0
ds_read_b128 v[164:167], v19 offset:1024
ds_read_b128 v[168:171], v19 offset:2048
ds_read_b128 v[172:175], v19 offset:3072
s_waitcnt lgkmcnt(0)
v_add_f32 v176, v96, v160
v_add_f32 v177, v97, v161
v_add_f32 v178, v112, v168
v_add_f32 v179, v113, v169
v_mul_f32 v176, 0xbfb8aa3b, v176
v_mul_f32 v177, 0xbfb8aa3b, v177
v_exp_f32 v176, v176
v_exp_f32 v177, v177
v_add_f32 v176, 1.0, v176
v_add_f32 v177, 1.0, v177
v_rcp_f32 v176, v176
v_rcp_f32 v177, v177
v_mul_f32 v176, v176, v178
v_mul_f32 v177, v177, v179
v_cvt_pk_bf16_f32 v184, v176, v177
v_add_f32 v180, v98, v162
v_add_f32 v181, v99, v163
v_add_f32 v182, v114, v170
v_add_f32 v183, v115, v171
v_mul_f32 v180, 0xbfb8aa3b, v180
v_mul_f32 v181, 0xbfb8aa3b, v181
v_exp_f32 v180, v180
v_exp_f32 v181, v181
v_add_f32 v180, 1.0, v180
v_add_f32 v181, 1.0, v181
v_rcp_f32 v180, v180
v_rcp_f32 v181, v181
v_mul_f32 v180, v180, v182
v_mul_f32 v181, v181, v183
v_cvt_pk_bf16_f32 v185, v180, v181
v_add_f32 v176, v100, v164
v_add_f32 v177, v101, v165
v_add_f32 v178, v116, v172
v_add_f32 v179, v117, v173
v_mul_f32 v176, 0xbfb8aa3b, v176
v_mul_f32 v177, 0xbfb8aa3b, v177
v_exp_f32 v176, v176
v_exp_f32 v177, v177
v_add_f32 v176, 1.0, v176
v_add_f32 v177, 1.0, v177
v_rcp_f32 v176, v176
v_rcp_f32 v177, v177
v_mul_f32 v176, v176, v178
v_mul_f32 v177, v177, v179
v_cvt_pk_bf16_f32 v186, v176, v177
v_add_f32 v180, v102, v166
v_add_f32 v181, v103, v167
v_add_f32 v182, v118, v174
v_add_f32 v183, v119, v175
v_mul_f32 v180, 0xbfb8aa3b, v180
v_mul_f32 v181, 0xbfb8aa3b, v181
v_exp_f32 v180, v180
v_exp_f32 v181, v181
v_add_f32 v180, 1.0, v180
v_add_f32 v181, 1.0, v181
v_rcp_f32 v180, v180
v_rcp_f32 v181, v181
v_mul_f32 v180, v180, v182
v_mul_f32 v181, v181, v183
v_cvt_pk_bf16_f32 v187, v180, v181
s_cmp_ge_u32 s45, 11
s_cbranch_scc1 Lno3
buffer_store_dwordx4 v[184:187], v1, s[32:35], s59 offen offset:0 sc1
Lno3:
s_waitcnt vmcnt(0)
s_waitcnt lgkmcnt(0)
s_barrier
s_cmp_lg_u32 s46, 7
s_cbranch_scc1 Ls27
s_lshl_b32 s58, s44, 5
s_lshl_b32 s51, s45, 0
s_add_u32 s58, s58, s51
s_lshl_b32 s50, s58, 2
s_add_u32 s50, s50, 57344
v_mov_b32 v6, s47
v_mov_b32 v7, 0
s_mov_b64 exec, 1
buffer_store_dword v6, v7, s[32:35], s50 offen sc1
s_mov_b64 exec, -1
Ls27:
s_and_b32 s49, s1, 1
s_lshl_b32 s49, s49, 5
v_xor_b32 v6, s49, v2
s_lshl_b32 s49, s1, 11
s_lshl_b32 s51, s56, 10
s_add_u32 s49, s49, s51
s_add_u32 s49, s49, 0
v_add_u32 v50, s49, v6
s_lshl_b32 s49, s56, 11
s_sub_u32 s49, 1024, s49
v_add_u32 v51, s49, v50
v_add_u32 v52, 65536, v50
v_add_u32 v53, 65536, v51
v_add_u32 v54, 131072, v50
v_add_u32 v55, 131072, v51
ds_read_b64_tr_b16 v[24:25], v50 offset:32768
ds_read_b64_tr_b16 v[26:27], v50 offset:33024
ds_read_b64_tr_b16 v[28:29], v51 offset:32768
ds_read_b64_tr_b16 v[30:31], v51 offset:33024
ds_read_b64_tr_b16 v[32:33], v50 offset:40960
ds_read_b64_tr_b16 v[34:35], v50 offset:41216
ds_read_b64_tr_b16 v[36:37], v51 offset:40960
ds_read_b64_tr_b16 v[38:39], v51 offset:41216
ds_read_b64_tr_b16 v[40:41], v50 offset:50176
ds_read_b64_tr_b16 v[42:43], v50 offset:50432
ds_read_b64_tr_b16 v[44:45], v51 offset:50176
ds_read_b64_tr_b16 v[46:47], v51 offset:50432
s_add_u32 m0, s95, 91136
s_add_u32 s49, s94, 114688
buffer_load_dwordx4 v21, s[24:27], s49 offen lds
s_add_u32 m0, s95, 99328
s_add_u32 s49, s94, 131072
buffer_load_dwordx4 v21, s[24:27], s49 offen lds
s_add_u32 m0, s95, 107520
s_add_u32 s49, s94, 147456
buffer_load_dwordx4 v21, s[24:27], s49 offen lds
s_add_u32 m0, s95, 0
s_add_u32 s49, s94, 163840
buffer_load_dwordx4 v21, s[24:27], s49 offen lds
s_add_u32 m0, s95, 8192
s_add_u32 s49, s94, 180224
buffer_load_dwordx4 v21, s[24:27], s49 offen lds
s_add_u32 m0, s95, 16384
s_add_u32 s49, s94, 196608
buffer_load_dwordx4 v21, s[24:27], s49 offen lds
s_add_u32 m0, s95, 24576
s_add_u32 s49, s94, 212992
buffer_load_dwordx4 v21, s[24:27], s49 offen lds
s_add_u32 m0, s95, 148480
s_add_u32 s49, s94, 229376
buffer_load_dwordx4 v21, s[24:27], s49 offen lds
s_add_u32 m0, s95, 115712
s_add_u32 s49, s94, 245760
buffer_load_dwordx4 v21, s[24:27], s49 offen lds
s_add_u32 m0, s95, 123904
s_add_u32 s49, s94, 262144
buffer_load_dwordx4 v21, s[24:27], s49 offen lds
s_add_u32 m0, s95, 132096
s_add_u32 s49, s94, 278528
buffer_load_dwordx4 v21, s[24:27], s49 offen lds
s_add_u32 m0, s95, 140288
s_add_u32 s49, s94, 294912
buffer_load_dwordx4 v21, s[24:27], s49 offen lds
s_waitcnt lgkmcnt(0)
s_barrier
s_add_u32 m0, s95, 32768
s_add_u32 s49, s94, 311296
buffer_load_dwordx4 v21, s[24:27], s49 offen lds
s_add_u32 m0, s95, 40960
s_add_u32 s49, s94, 327680
buffer_load_dwordx4 v21, s[24:27], s49 offen lds
s_add_u32 m0, s95, 50176
s_add_u32 s49, s94, 344064
buffer_load_dwordx4 v21, s[24:27], s49 offen lds
s_cmp_lg_u32 s46, 0
s_cbranch_scc1 Lg28
v_lshrrev_b32 v7, 2, v1
v_and_b32 v7, 60, v7
s_lshr_b32 s49, s55, 2
s_lshl_b32 s50, s49, 5
s_lshl_b32 s50, s50, 2
s_add_u32 s50, s50, 57344
s_mov_b32 s52, 400000
Lp29:
buffer_load_dword v22, v7, s[32:35], s50 offen sc1
s_waitcnt vmcnt(0)
v_cmp_ne_u32 vcc, s47, v22
s_nop 0
s_cbranch_vccz Ld30
s_sub_u32 s52, s52, 1
s_cmp_lg_u32 s52, 0
s_cbranch_scc1 Lp29
Ld30:
Lg28:
s_waitcnt vmcnt(0)
s_waitcnt lgkmcnt(0)
s_barrier
s_mul_i32 s58, s55, 88064
s_lshl_b32 s51, s93, 10
s_add_u32 s58, s58, s51
s_add_u32 s58, s58, 9437184
buffer_load_dwordx4 v[168:171], v1, s[32:35], s58 offen offset:0 sc1
buffer_load_dwordx4 v[172:175], v1, s[32:35], s58 offen offset:1024 sc1
buffer_load_dwordx4 v[176:179], v1, s[32:35], s58 offen offset:2048 sc1
buffer_load_dwordx4 v[180:183], v1, s[32:35], s58 offen offset:3072 sc1
s_add_u32 s58, s58, 4096
buffer_load_dwordx4 v[184:187], v1, s[32:35], s58 offen offset:0 sc1
buffer_load_dwordx4 v[188:191], v1, s[32:35], s58 offen offset:1024 sc1
buffer_load_dwordx4 v[192:195], v1, s[32:35], s58 offen offset:2048 sc1
buffer_load_dwordx4 v[196:199], v1, s[32:35], s58 offen offset:3072 sc1
s_waitcnt vmcnt(7)
v_mfma_f32_32x32x16_bf16 v[64:79], v[24:27], v[168:171], 0
s_add_u32 s58, s58, 4096
buffer_load_dwordx4 v[200:203], v1, s[32:35], s58 offen offset:0 sc1
v_mfma_f32_32x32x16_bf16 v[80:95], v[28:31], v[168:171], 0
s_waitcnt vmcnt(7)
v_mfma_f32_32x32x16_bf16 v[64:79], v[32:35], v[172:175], v[64:79]
ds_read_b64_tr_b16 v[24:25], v50 offset:58368
ds_read_b64_tr_b16 v[26:27], v50 offset:58624
ds_read_b64_tr_b16 v[28:29], v51 offset:58368
ds_read_b64_tr_b16 v[30:31], v51 offset:58624
buffer_load_dwordx4 v[204:207], v1, s[32:35], s58 offen offset:1024 sc1
v_mfma_f32_32x32x16_bf16 v[80:95], v[36:39], v[172:175], v[80:95]
s_waitcnt vmcnt(7)
v_mfma_f32_32x32x16_bf16 v[64:79], v[40:43], v[176:179], v[64:79]
ds_read_b64_tr_b16 v[32:33], v52 offset:1024
ds_read_b64_tr_b16 v[34:35], v52 offset:1280
ds_read_b64_tr_b16 v[36:37], v53 offset:1024
ds_read_b64_tr_b16 v[38:39], v53 offset:1280
buffer_load_dwordx4 v[208:211], v1, s[32:35], s58 offen offset:2048 sc1
v_mfma_f32_32x32x16_bf16 v[80:95], v[44:47], v[176:179], v[80:95]
s_waitcnt lgkmcnt(4)
s_waitcnt vmcnt(7)
v_mfma_f32_32x32x16_bf16 v[64:79], v[24:27], v[180:183], v[64:79]
ds_read_b64_tr_b16 v[40:41], v52 offset:9216
ds_read_b64_tr_b16 v[42:43], v52 offset:9472
ds_read_b64_tr_b16 v[44:45], v53 offset:9216
ds_read_b64_tr_b16 v[46:47], v53 offset:9472
buffer_load_dwordx4 v[212:215], v1, s[32:35], s58 offen offset:3072 sc1
v_mfma_f32_32x32x16_bf16 v[80:95], v[28:31], v[180:183], v[80:95]
s_waitcnt lgkmcnt(4)
s_waitcnt vmcnt(7)
v_mfma_f32_32x32x16_bf16 v[64:79], v[32:35], v[184:187], v[64:79]
ds_read_b64_tr_b16 v[24:25], v52 offset:17408
ds_read_b64_tr_b16 v[26:27], v52 offset:17664
ds_read_b64_tr_b16 v[28:29], v53 offset:17408
ds_read_b64_tr_b16 v[30:31], v53 offset:17664
s_add_u32 s58, s58, 4096
buffer_load_dwordx4 v[216:219], v1, s[32:35], s58 offen offset:0 sc1
v_mfma_f32_32x32x16_bf16 v[80:95], v[36:39], v[184:187], v[80:95]
s_waitcnt lgkmcnt(4)
s_waitcnt vmcnt(7)
v_mfma_f32_32x32x16_bf16 v[64:79], v[40:43], v[188:191], v[64:79]
ds_read_b64_tr_b16 v[32:33], v52 offset:25600
ds_read_b64_tr_b16 v[34:35], v52 offset:25856
ds_read_b64_tr_b16 v[36:37], v53 offset:25600
ds_read_b64_tr_b16 v[38:39], v53 offset:25856
buffer_load_dwordx4 v[220:223], v1, s[32:35], s58 offen offset:1024 sc1
v_mfma_f32_32x32x16_bf16 v[80:95], v[44:47], v[188:191], v[80:95]
s_waitcnt lgkmcnt(4)
s_waitcnt vmcnt(7)
v_mfma_f32_32x32x16_bf16 v[64:79], v[24:27], v[192:195], v[64:79]
ds_read_b64_tr_b16 v[40:41], v52 offset:33792
ds_read_b64_tr_b16 v[42:43], v52 offset:34048
ds_read_b64_tr_b16 v[44:45], v53 offset:33792
ds_read_b64_tr_b16 v[46:47], v53 offset:34048
buffer_load_dwordx4 v[224:227], v1, s[32:35], s58 offen offset:2048 sc1
v_mfma_f32_32x32x16_bf16 v[80:95], v[28:31], v[192:195], v[80:95]
s_waitcnt lgkmcnt(4)
s_waitcnt vmcnt(7)
v_mfma_f32_32x32x16_bf16 v[64:79], v[32:35], v[196:199], v[64:79]
ds_read_b64_tr_b16 v[24:25], v52 offset:41984
ds_read_b64_tr_b16 v[26:27], v52 offset:42240
ds_read_b64_tr_b16 v[28:29], v53 offset:41984
ds_read_b64_tr_b16 v[30:31], v53 offset:42240
buffer_load_dwordx4 v[228:231], v1, s[32:35], s58 offen offset:3072 sc1
v_mfma_f32_32x32x16_bf16 v[80:95], v[36:39], v[196:199], v[80:95]
s_waitcnt lgkmcnt(4)
s_waitcnt vmcnt(7)
v_mfma_f32_32x32x16_bf16 v[64:79], v[40:43], v[200:203], v[64:79]
ds_read_b64_tr_b16 v[32:33], v50 offset:0
ds_read_b64_tr_b16 v[34:35], v50 offset:256
ds_read_b64_tr_b16 v[36:37], v51 offset:0
ds_read_b64_tr_b16 v[38:39], v51 offset:256
s_add_u32 s58, s58, 4096
buffer_load_dwordx4 v[232:235], v1, s[32:35], s58 offen offset:0 sc1
v_mfma_f32_32x32x16_bf16 v[80:95], v[44:47], v[200:203], v[80:95]
s_waitcnt lgkmcnt(4)
s_waitcnt vmcnt(7)
v_mfma_f32_32x32x16_bf16 v[64:79], v[24:27], v[204:207], v[64:79]
ds_read_b64_tr_b16 v[40:41], v50 offset:8192
ds_read_b64_tr_b16 v[42:43], v50 offset:8448
ds_read_b64_tr_b16 v[44:45], v51 offset:8192
ds_read_b64_tr_b16 v[46:47], v51 offset:8448
buffer_load_dwordx4 v[236:239], v1, s[32:35], s58 offen offset:1024 sc1
v_mfma_f32_32x32x16_bf16 v[80:95], v[28:31], v[204:207], v[80:95]
s_waitcnt lgkmcnt(4)
s_waitcnt vmcnt(7)
v_mfma_f32_32x32x16_bf16 v[64:79], v[32:35], v[208:211], v[64:79]
ds_read_b64_tr_b16 v[24:25], v50 offset:16384
ds_read_b64_tr_b16 v[26:27], v50 offset:16640
ds_read_b64_tr_b16 v[28:29], v51 offset:16384
ds_read_b64_tr_b16 v[30:31], v51 offset:16640
buffer_load_dwordx4 v[240:243], v1, s[32:35], s58 offen offset:2048 sc1
v_mfma_f32_32x32x16_bf16 v[80:95], v[36:39], v[208:211], v[80:95]
s_waitcnt lgkmcnt(4)
s_waitcnt vmcnt(7)
v_mfma_f32_32x32x16_bf16 v[64:79], v[40:43], v[212:215], v[64:79]
ds_read_b64_tr_b16 v[32:33], v50 offset:24576
ds_read_b64_tr_b16 v[34:35], v50 offset:24832
ds_read_b64_tr_b16 v[36:37], v51 offset:24576
ds_read_b64_tr_b16 v[38:39], v51 offset:24832
buffer_load_dwordx4 v[244:247], v1, s[32:35], s58 offen offset:3072 sc1
v_mfma_f32_32x32x16_bf16 v[80:95], v[44:47], v[212:215], v[80:95]
s_waitcnt lgkmcnt(4)
s_waitcnt vmcnt(7)
v_mfma_f32_32x32x16_bf16 v[64:79], v[24:27], v[216:219], v[64:79]
ds_read_b64_tr_b16 v[40:41], v54 offset:17408
ds_read_b64_tr_b16 v[42:43], v54 offset:17664
ds_read_b64_tr_b16 v[44:45], v55 offset:17408
ds_read_b64_tr_b16 v[46:47], v55 offset:17664
s_add_u32 s58, s58, 4096
buffer_load_dwordx4 v[248:251], v1, s[32:35], s58 offen offset:0 sc1
v_mfma_f32_32x32x16_bf16 v[80:95], v[28:31], v[216:219], v[80:95]
s_waitcnt lgkmcnt(4)
s_waitcnt vmcnt(7)
v_mfma_f32_32x32x16_bf16 v[64:79], v[32:35], v[220:223], v[64:79]
ds_read_b64_tr_b16 v[24:25], v52 offset:50176
ds_read_b64_tr_b16 v[26:27], v52 offset:50432
ds_read_b64_tr_b16 v[28:29], v53 offset:50176
ds_read_b64_tr_b16 v[30:31], v53 offset:50432
s_cmp_ge_u32 s1, 2
s_cselect_b32 s58, 0x7ff00000, s58
buffer_load_dwordx4 v[252:255], v1, s[32:35], s58 offen offset:1024 sc1
v_mfma_f32_32x32x16_bf16 v[80:95], v[36:39], v[220:223], v[80:95]
s_waitcnt lgkmcnt(4)
s_waitcnt vmcnt(7)
v_mfma_f32_32x32x16_bf16 v[64:79], v[40:43], v[224:227], v[64:79]
ds_read_b64_tr_b16 v[32:33], v52 offset:58368
ds_read_b64_tr_b16 v[34:35], v52 offset:58624
ds_read_b64_tr_b16 v[36:37], v53 offset:58368
ds_read_b64_tr_b16 v[38:39], v53 offset:58624
v_mfma_f32_32x32x16_bf16 v[80:95], v[44:47], v[224:227], v[80:95]
s_waitcnt lgkmcnt(4)
s_waitcnt vmcnt(6)
v_mfma_f32_32x32x16_bf16 v[64:79], v[24:27], v[228:231], v[64:79]
ds_read_b64_tr_b16 v[40:41], v54 offset:1024
ds_read_b64_tr_b16 v[42:43], v54 offset:1280
ds_read_b64_tr_b16 v[44:45], v55 offset:1024
ds_read_b64_tr_b16 v[46:47], v55 offset:1280
v_mfma_f32_32x32x16_bf16 v[80:95], v[28:31], v[228:231], v[80:95]
s_waitcnt lgkmcnt(4)
s_waitcnt vmcnt(5)
v_mfma_f32_32x32x16_bf16 v[64:79], v[32:35], v[232:235], v[64:79]
ds_read_b64_tr_b16 v[24:25], v54 offset:9216
ds_read_b64_tr_b16 v[26:27], v54 offset:9472
ds_read_b64_tr_b16 v[28:29], v55 offset:9216
ds_read_b64_tr_b16 v[30:31], v55 offset:9472
v_mfma_f32_32x32x16_bf16 v[80:95], v[36:39], v[232:235], v[80:95]
s_waitcnt lgkmcnt(4)
s_waitcnt vmcnt(4)
v_mfma_f32_32x32x16_bf16 v[64:79], v[40:43], v[236:239], v[64:79]
ds_read_b64_tr_b16 v[32:33], v50 offset:32768
ds_read_b64_tr_b16 v[34:35], v50 offset:33024
ds_read_b64_tr_b16 v[36:37], v51 offset:32768
ds_read_b64_tr_b16 v[38:39], v51 offset:33024
v_mfma_f32_32x32x16_bf16 v[80:95], v[44:47], v[236:239], v[80:95]
s_waitcnt lgkmcnt(4)
s_waitcnt vmcnt(3)
v_mfma_f32_32x32x16_bf16 v[64:79], v[24:27], v[240:243], v[64:79]
ds_read_b64_tr_b16 v[40:41], v50 offset:40960
ds_read_b64_tr_b16 v[42:43], v50 offset:41216
ds_read_b64_tr_b16 v[44:45], v51 offset:40960
ds_read_b64_tr_b16 v[46:47], v51 offset:41216
v_mfma_f32_32x32x16_bf16 v[80:95], v[28:31], v[240:243], v[80:95]
s_waitcnt lgkmcnt(4)
s_waitcnt vmcnt(2)
v_mfma_f32_32x32x16_bf16 v[64:79], v[32:35], v[244:247], v[64:79]
ds_read_b64_tr_b16 v[24:25], v50 offset:50176
ds_read_b64_tr_b16 v[26:27], v50 offset:50432
ds_read_b64_tr_b16 v[28:29], v51 offset:50176
ds_read_b64_tr_b16 v[30:31], v51 offset:50432
v_mfma_f32_32x32x16_bf16 v[80:95], v[36:39], v[244:247], v[80:95]
s_waitcnt lgkmcnt(4)
s_waitcnt vmcnt(1)
v_mfma_f32_32x32x16_bf16 v[64:79], v[40:43], v[248:251], v[64:79]
v_mfma_f32_32x32x16_bf16 v[80:95], v[44:47], v[248:251], v[80:95]
s_waitcnt lgkmcnt(0)
s_waitcnt vmcnt(0)
v_mfma_f32_32x32x16_bf16 v[64:79], v[24:27], v[252:255], v[64:79]
v_mfma_f32_32x32x16_bf16 v[80:95], v[28:31], v[252:255], v[80:95]
s_xor_b32 s50, s46, 2
s_mul_i32 s49, s50, 6144
s_add_u32 s49, s49, 0
v_add_u32 v43, s49, v1
s_xor_b32 s50, s46, 4
s_mul_i32 s49, s50, 6144
s_add_u32 s49, s49, 2048
v_add_u32 v44, s49, v1
s_xor_b32 s50, s46, 6
s_mul_i32 s49, s50, 6144
s_add_u32 s49, s49, 4096
v_add_u32 v45, s49, v1
s_mul_i32 s49, s46, 6144
s_add_u32 s49, s49, 0
v_add_u32 v46, s49, v1
s_lshl_b32 s49, s1, 6
s_add_u32 s49, s49, 163584
v_lshrrev_b32 v6, 9, v1
v_lshlrev_b32 v6, 4, v6
v_add_u32 v6, s49, v6
ds_read_b128 v[120:123], v6 offset:0
ds_read_b128 v[124:127], v6 offset:32
s_barrier
ds_write_b128 v44, v[80:83] offset:0
ds_write_b128 v44, v[84:87] offset:1024
ds_write_b128 v45, v[88:91] offset:0
ds_write_b128 v45, v[92:95] offset:1024
ds_write_b128 v43, v[72:75] offset:0
ds_write_b128 v43, v[76:79] offset:1024
s_waitcnt lgkmcnt(0)
s_barrier
ds_read_b128 v[96:99], v46 offset:0
ds_read_b128 v[100:103], v46 offset:1024
ds_read_b128 v[104:107], v46 offset:2048
ds_read_b128 v[108:111], v46 offset:3072
ds_read_b128 v[112:115], v46 offset:4096
ds_read_b128 v[116:119], v46 offset:5120
v_lshlrev_b32 v24, 16, v8
v_and_b32 v25, s54, v8
v_lshlrev_b32 v26, 16, v9
v_and_b32 v27, s54, v9
v_lshlrev_b32 v28, 16, v10
v_and_b32 v29, s54, v10
v_lshlrev_b32 v30, 16, v11
v_and_b32 v31, s54, v11
s_waitcnt lgkmcnt(0)
v_add_f32 v96, v96, v104
v_add_f32 v64, v64, v112
v_add_f32 v97, v97, v105
v_add_f32 v65, v65, v113
v_add_f32 v98, v98, v106
v_add_f32 v66, v66, v114
v_add_f32 v99, v99, v107
v_add_f32 v67, v67, v115
v_add_f32 v100, v100, v108
v_add_f32 v68, v68, v116
v_add_f32 v101, v101, v109
v_add_f32 v69, v69, v117
v_add_f32 v102, v102, v110
v_add_f32 v70, v70, v118
v_add_f32 v103, v103, v111
v_add_f32 v71, v71, v119
v_add_f32 v64, v64, v96
v_add_f32 v65, v65, v97
v_add_f32 v66, v66, v98
v_add_f32 v67, v67, v99
v_add_f32 v68, v68, v100
v_add_f32 v69, v69, v101
v_add_f32 v70, v70, v102
v_add_f32 v71, v71, v103
v_fmac_f32 v24, v64, v120
v_fmac_f32 v25, v65, v121
v_fmac_f32 v26, v66, v122
v_fmac_f32 v27, v67, v123
v_fmac_f32 v28, v68, v124
v_fmac_f32 v29, v69, v125
v_fmac_f32 v30, v70, v126
v_fmac_f32 v31, v71, v127
v_cvt_pk_bf16_f32 v8, v24, v25
v_cvt_pk_bf16_f32 v9, v26, v27
v_cvt_pk_bf16_f32 v10, v28, v29
v_cvt_pk_bf16_f32 v11, v30, v31
s_nop 0
v_permlane32_swap_b32 v8, v10
v_permlane32_swap_b32 v9, v11
v_and_b32 v6, 0x1f0, v1
v_lshlrev_b32 v6, 6, v6
v_lshrrev_b32 v7, 9, v1
v_lshl_add_u32 v62, v7, 4, v6
buffer_store_dwordx4 v[8:11], v62, s[28:31], s3 offen
Lfin:
s_waitcnt vmcnt(0)
Lend:
s_endpgm
.section .rodata,"a"
.p2align 6
.amdhsa_kernel adaLN_cond__sliding_block__glu_gated_glu__prompt_kernel
  .amdhsa_next_free_vgpr 256
  .amdhsa_next_free_sgpr 102
  .amdhsa_accum_offset 256
  .amdhsa_group_segment_fixed_size 0
  .amdhsa_kernarg_size 96
  .amdhsa_user_sgpr_count 2
  .amdhsa_user_sgpr_kernarg_segment_ptr 1
  .amdhsa_system_sgpr_workgroup_id_x 1
.end_amdhsa_kernel
```
